```python
import torch

def _softmax(x, axis=-1):
    return torch.softmax(x, dim=axis)
def _gelu(x):
    return torch.nn.functional.gelu(x, approximate="tanh")
def _silu(x):
    return torch.nn.functional.silu(x)
def _sigmoid(x):
    return torch.sigmoid(x)
def _layernorm(x, axis=-1, eps=1e-5):
    m = x.mean(dim=axis, keepdim=True)
    v = x.var(dim=axis, keepdim=True, unbiased=False)
    return (x - m) / torch.sqrt(v + eps)
def _scatter_add(tgt, idx, src, axis=0):
    return tgt.clone().index_add_(axis, idx, src)
def _segment_sum(src, seg, n):
    out = torch.zeros((n,) + src.shape[1:], dtype=src.dtype)
    return out.index_add_(0, seg, src)
def _pad(x, pw):
    flat = tuple(v for pair in reversed(pw) for v in pair)
    return torch.nn.functional.pad(x, flat)

kernel_name = 'standalone__edge_featured_mpnn_mpnn__graph'

def setup_inputs():

    _w = (lambda a: (lambda t: t.to(torch.bfloat16) if t.is_floating_point() else t)(torch.as_tensor(a)))
    N, deg, D, De = 12500, 32, 128, max(4, 1)
    E = N * deg
    H = 2 * D
    return {
        "x": _w((lambda *s: torch.randn(*s, dtype=torch.bfloat16) * 0.05)(N, D)),
        "e_attr": _w((lambda *s: torch.randn(*s, dtype=torch.bfloat16) * 1.6)(E, De)),
        "src": _w((lambda lo, hi, *s: torch.randint(lo, hi, s))(0, N, E).to(torch.int64)),
        "dst": _w((lambda lo, hi, *s: torch.randint(lo, hi, s))(0, N, E).to(torch.int64)),
        "w1": _w((lambda *s: torch.randn(*s, dtype=torch.bfloat16) * 1.6)(2 * D + De, H) * (1.0 / (2 * D + De) ** 0.5)),
        "b1": _w((lambda *s: torch.randn(*s, dtype=torch.bfloat16) * 3.2)(H) * 0.01),
        "w2": _w((lambda *s: torch.randn(*s, dtype=torch.bfloat16) * 0.05)(H, D) * (1.0 / H ** 0.5)),
        "b2": _w((lambda *s: torch.randn(*s, dtype=torch.bfloat16) * 0.1)(D) * 0.01),
    }

def reference(x, e_attr, src, dst, w1, b1, w2, b2):
    N, D = x.shape
    h_src = x[src]
    h_dst = x[dst]
    m_in = torch.concatenate([h_src, h_dst, e_attr], axis=-1)
    h = _silu(m_in @ w1 + b1)
    msg = h @ w2 + b2
    return _segment_sum(msg, dst, N)
```

```asm
; @launch kernel=k1_kernel grid=(461,1,1) block=(512,1,1) lds=81920
; @launch kernel=k2_kernel grid=(256,1,1) block=(768,1,1) lds=156672
.amdgcn_target "amdgcn-amd-amdhsa--gfx950"
.text
.globl k1_kernel
.p2align 8
.type k1_kernel,@function
k1_kernel:
    s_cmp_ge_u32 s2, 461
    s_cbranch_scc1 L1_exit2
    s_load_dwordx16 s[4:19], s[0:1], 0
    s_load_dwordx4 s[20:23], s[0:1], 64
    s_load_dwordx2 s[24:25], s[0:1], 80
    v_and_b32 v1, 63, v0
    v_lshrrev_b32 v2, 6, v0
    s_nop 0
    v_readfirstlane_b32 s3, v2
    s_cmp_ge_u32 s2, 32
    s_cbranch_scc1 L_pe1
    s_getpc_b64 s[64:65]
L_pc1:
    s_sub_u32 s64, s64, L_pc1-k1_kernel
    s_subb_u32 s65, s65, 0
    s_mul_i32 s66, s3, 3072
    v_min_u32 v122, 23, v1
    v_lshl_add_u32 v122, v122, 7, s66
    v_min_u32 v122, L2_last-k1_kernel-4, v122
    v_mov_b32 v123, s65
    v_add_co_u32 v122, vcc, s64, v122
    s_nop 1
    v_addc_co_u32 v123, vcc, 0, v123, vcc
    global_load_dword v125, v[122:123], off
L_pe1:
    s_cmp_gt_u32 s2, 210
    s_cbranch_scc1 L1_part
    s_cmp_eq_u32 s2, 210
    s_cbranch_scc1 L1_w2
    s_bfe_u32 s27, s2, 0x10003
    s_lshr_b32 s28, s2, 4
    s_lshl_b32 s28, s28, 3
    s_and_b32 s29, s2, 7
    s_add_u32 s28, s28, s29
    s_cmp_ge_u32 s2, 208
    s_cselect_b32 s27, s29, s27
    s_cselect_b32 s61, 65536, 0
    s_cbranch_scc1 L1_g1
    s_cmp_ge_u32 s28, 98
    s_cbranch_scc1 L1_exit2
L1_g1:
    v_lshrrev_b32 v18, 4, v1
    v_and_b32 v19, 15, v1
    v_lshlrev_b32 v24, 2, v18
    v_xor_b32 v24, v24, v19
    v_lshlrev_b32 v24, 4, v24
    v_lshl_or_b32 v124, v18, 9, v24
    v_add_u32 v20, 0, v18
    v_xor_b32 v20, v20, v19
    v_lshlrev_b32 v20, 4, v20
    v_lshl_or_b32 v25, v18, 8, v20
    v_add_u32 v20, 4, v18
    v_xor_b32 v20, v20, v19
    v_lshlrev_b32 v20, 4, v20
    v_lshl_or_b32 v26, v18, 8, v20
    v_add_u32 v20, 8, v18
    v_xor_b32 v20, v20, v19
    v_lshlrev_b32 v20, 4, v20
    v_lshl_or_b32 v27, v18, 8, v20
    v_add_u32 v20, 12, v18
    v_xor_b32 v20, v20, v19
    v_lshlrev_b32 v20, 4, v20
    v_lshl_or_b32 v28, v18, 8, v20
    v_mov_b32 v2, 0
    s_lshl_b32 s43, s3, 13
    s_lshl_b32 s30, s27, 8
    s_add_u32 s43, s43, s30
    s_add_u32 s43, s43, s61
    s_lshl_b32 s31, s3, 12
    s_lshl_b32 s29, s28, 15
    s_add_u32 s29, s29, s31
    s_add_u32 m0, s31, 32768
    s_and_b32 s40, s3, 1
    s_lshr_b32 s41, s3, 1
    v_and_b32 v7, 31, v1
    v_lshlrev_b32 v20, 1, v7
    s_lshl_b32 s42, s40, 7
    s_add_u32 s42, s42, s30
    s_waitcnt lgkmcnt(0)
    s_mov_b32 s36, s4
    s_mov_b32 s37, s5
    s_mov_b32 s38, 3200000
    s_mov_b32 s39, 0x00020000
    buffer_load_dwordx4 v25, s[36:39], s29 offen lds
    s_add_u32 m0, m0, 1024
    s_add_u32 s29, s29, 1024
    buffer_load_dwordx4 v26, s[36:39], s29 offen lds
    s_add_u32 m0, m0, 1024
    s_add_u32 s29, s29, 1024
    buffer_load_dwordx4 v27, s[36:39], s29 offen lds
    s_add_u32 m0, m0, 1024
    s_add_u32 s29, s29, 1024
    buffer_load_dwordx4 v28, s[36:39], s29 offen lds
    s_mov_b32 m0, s31
    s_mov_b32 s32, s12
    s_mov_b32 s33, s13
    s_mov_b32 s34, 133120
    s_mov_b32 s35, 0x00020000
    buffer_load_dwordx4 v124, s[32:35], s43 offen lds
    s_add_u32 m0, m0, 1024
    s_add_u32 s43, s43, 2048
    buffer_load_dwordx4 v124, s[32:35], s43 offen lds
    s_add_u32 m0, m0, 1024
    s_add_u32 s43, s43, 2048
    buffer_load_dwordx4 v124, s[32:35], s43 offen lds
    s_add_u32 m0, m0, 1024
    s_add_u32 s43, s43, 2048
    buffer_load_dwordx4 v124, s[32:35], s43 offen lds
    s_add_u32 m0, m0, 1024
    s_add_u32 s43, s43, 2048
    v_bfe_u32 v18, v1, 2, 2
    v_lshrrev_b32 v6, 5, v1
    v_lshl_add_u32 v19, v6, 3, v18
    v_lshlrev_b32 v19, 8, v19
    v_bfe_u32 v20, v1, 4, 1
    v_lshlrev_b32 v20, 5, v20
    v_and_b32 v21, 3, v1
    v_lshl_add_u32 v20, v21, 3, v20
    v_add_u32 v19, v19, v20
    s_lshl_b32 s42, s40, 1
    v_xor_b32 v20, s42, v18
    v_lshl_add_u32 v120, v20, 6, v19
    v_xor_b32 v20, 1, v20
    v_lshl_add_u32 v121, v20, 6, v19
    s_lshl_b32 s42, s41, 5
    v_add_u32 v19, s42, v7
    v_lshlrev_b32 v19, 8, v19
    v_and_b32 v20, 15, v1
    v_xor_b32 v20, v20, v6
    v_lshl_add_u32 v104, v20, 4, v19
    v_add_u32 v104, 32768, v104
    v_xor_b32 v105, 32, v104
    v_xor_b32 v106, 64, v104
    v_xor_b32 v107, 96, v104
    v_xor_b32 v108, 128, v104
    v_xor_b32 v109, 160, v104
    v_xor_b32 v110, 192, v104
    v_xor_b32 v111, 224, v104
    s_mov_b32 s44, s24
    s_mov_b32 s45, s25
    s_mov_b32 s46, 6400000
    s_mov_b32 s47, 0x00020000
    s_lshl_b32 s42, s28, 2
    s_add_u32 s42, s42, s41
    s_lshl_b32 s42, s42, 14
    s_lshl_b32 s48, s27, 1
    s_add_u32 s48, s48, s40
    s_lshl_b32 s48, s48, 7
    s_add_u32 s48, s42, s48
    s_lshl_b32 s30, s3, 11
    s_add_u32 s30, s30, 65536
    v_lshlrev_b32 v4, 9, v6
    v_lshl_add_u32 v4, v7, 2, v4
    v_add_u32 v4, s30, v4
    v_lshl_add_u32 v6, v1, 4, s30
    v_lshrrev_b32 v7, 3, v1
    v_lshlrev_b32 v7, 9, v7
    v_and_b32 v18, 7, v1
    v_lshl_add_u32 v7, v18, 4, v7
    s_mov_b32 s52, 3216550459
    s_mov_b32 s60, 1069066811
    v_mov_b32 v5, 0
    v_mov_b32 v125, 0x80008000
    s_setprio 3
    s_waitcnt vmcnt(0)
    s_barrier
    s_cmp_ge_u32 s2, 208
    s_cbranch_scc1 L1_w1b
    ds_read_b128 v[24:27], v104
    ds_read_b64_tr_b16 v[56:57], v120 offset:0
    ds_read_b64_tr_b16 v[58:59], v120 offset:1024
    ds_read_b128 v[28:31], v105
    ds_read_b64_tr_b16 v[60:61], v120 offset:4096
    ds_read_b64_tr_b16 v[62:63], v120 offset:5120
    ds_read_b128 v[32:35], v106
    ds_read_b64_tr_b16 v[64:65], v120 offset:8192
    ds_read_b64_tr_b16 v[66:67], v120 offset:9216
    ds_read_b128 v[36:39], v107
    ds_read_b64_tr_b16 v[68:69], v120 offset:12288
    ds_read_b64_tr_b16 v[70:71], v120 offset:13312
    ds_read_b128 v[40:43], v108
    ds_read_b64_tr_b16 v[72:73], v120 offset:16384
    ds_read_b64_tr_b16 v[74:75], v120 offset:17408
    s_waitcnt lgkmcnt(12)
    v_mfma_f32_32x32x16_bf16 v[8:23], v[24:27], v[56:59], 0
    ds_read_b128 v[44:47], v109
    ds_read_b64_tr_b16 v[76:77], v120 offset:20480
    ds_read_b64_tr_b16 v[78:79], v120 offset:21504
    s_waitcnt lgkmcnt(12)
    v_mfma_f32_32x32x16_bf16 v[8:23], v[28:31], v[60:63], v[8:23]
    ds_read_b128 v[48:51], v110
    ds_read_b64_tr_b16 v[80:81], v120 offset:24576
    ds_read_b64_tr_b16 v[82:83], v120 offset:25600
    s_waitcnt lgkmcnt(12)
    v_mfma_f32_32x32x16_bf16 v[8:23], v[32:35], v[64:67], v[8:23]
    ds_read_b128 v[52:55], v111
    ds_read_b64_tr_b16 v[84:85], v120 offset:28672
    ds_read_b64_tr_b16 v[86:87], v120 offset:29696
    s_waitcnt lgkmcnt(12)
    v_mfma_f32_32x32x16_bf16 v[8:23], v[36:39], v[68:71], v[8:23]
    ds_read_b64_tr_b16 v[88:89], v121 offset:0
    ds_read_b64_tr_b16 v[90:91], v121 offset:1024
    s_waitcnt lgkmcnt(11)
    v_mfma_f32_32x32x16_bf16 v[8:23], v[40:43], v[72:75], v[8:23]
    ds_read_b64_tr_b16 v[92:93], v121 offset:4096
    ds_read_b64_tr_b16 v[94:95], v121 offset:5120
    s_waitcnt lgkmcnt(10)
    v_mfma_f32_32x32x16_bf16 v[8:23], v[44:47], v[76:79], v[8:23]
    ds_read_b64_tr_b16 v[96:97], v121 offset:8192
    ds_read_b64_tr_b16 v[98:99], v121 offset:9216
    s_waitcnt lgkmcnt(9)
    v_mfma_f32_32x32x16_bf16 v[8:23], v[48:51], v[80:83], v[8:23]
    ds_read_b64_tr_b16 v[100:101], v121 offset:12288
    ds_read_b64_tr_b16 v[102:103], v121 offset:13312
    s_waitcnt lgkmcnt(8)
    v_mfma_f32_32x32x16_bf16 v[8:23], v[52:55], v[84:87], v[8:23]
    ds_read_b64_tr_b16 v[104:105], v121 offset:16384
    ds_read_b64_tr_b16 v[106:107], v121 offset:17408
    ds_read_b64_tr_b16 v[108:109], v121 offset:20480
    ds_read_b64_tr_b16 v[110:111], v121 offset:21504
    ds_read_b64_tr_b16 v[112:113], v121 offset:24576
    ds_read_b64_tr_b16 v[114:115], v121 offset:25600
    ds_read_b64_tr_b16 v[116:117], v121 offset:28672
    ds_read_b64_tr_b16 v[118:119], v121 offset:29696
    s_waitcnt lgkmcnt(0)
    v_mfma_f32_32x32x16_bf16 v[56:71], v[24:27], v[88:91], 0
    v_mfma_f32_32x32x16_bf16 v[56:71], v[28:31], v[92:95], v[56:71]
    v_mfma_f32_32x32x16_bf16 v[56:71], v[32:35], v[96:99], v[56:71]
    v_mul_f32 v8, s52, v8
    v_mul_f32 v9, s52, v9
    v_mul_f32 v10, s52, v10
    v_mfma_f32_32x32x16_bf16 v[56:71], v[36:39], v[100:103], v[56:71]
    v_mul_f32 v11, s52, v11
    v_mul_f32 v12, s52, v12
    v_mul_f32 v13, s52, v13
    v_mfma_f32_32x32x16_bf16 v[56:71], v[40:43], v[104:107], v[56:71]
    v_mul_f32 v14, s52, v14
    v_mul_f32 v15, s52, v15
    v_mul_f32 v16, s52, v16
    v_mfma_f32_32x32x16_bf16 v[56:71], v[44:47], v[108:111], v[56:71]
    v_mul_f32 v17, s52, v17
    v_mul_f32 v18, s52, v18
    v_mul_f32 v19, s52, v19
    v_mfma_f32_32x32x16_bf16 v[56:71], v[48:51], v[112:115], v[56:71]
    v_mul_f32 v20, s52, v20
    v_mul_f32 v21, s52, v21
    v_mul_f32 v22, s52, v22
    v_mfma_f32_32x32x16_bf16 v[56:71], v[52:55], v[116:119], v[56:71]
    v_mul_f32 v23, s52, v23
    s_nop 10
    v_mul_f32 v56, s52, v56
    v_cvt_pk_bf16_f32 v72, v8, v56
    ds_write_b32 v4, v72 offset:0
    v_mul_f32 v57, s52, v57
    v_cvt_pk_bf16_f32 v73, v9, v57
    ds_write_b32 v4, v73 offset:128
    v_mul_f32 v58, s52, v58
    v_cvt_pk_bf16_f32 v74, v10, v58
    ds_write_b32 v4, v74 offset:256
    v_mul_f32 v59, s52, v59
    v_cvt_pk_bf16_f32 v75, v11, v59
    ds_write_b32 v4, v75 offset:384
    v_mul_f32 v60, s52, v60
    v_cvt_pk_bf16_f32 v76, v12, v60
    ds_write_b32 v4, v76 offset:1024
    v_mul_f32 v61, s52, v61
    v_cvt_pk_bf16_f32 v77, v13, v61
    ds_write_b32 v4, v77 offset:1152
    v_mul_f32 v62, s52, v62
    v_cvt_pk_bf16_f32 v78, v14, v62
    ds_write_b32 v4, v78 offset:1280
    v_mul_f32 v63, s52, v63
    v_cvt_pk_bf16_f32 v79, v15, v63
    ds_write_b32 v4, v79 offset:1408
    ds_read_b128 v[88:91], v6 offset:0
    ds_read_b128 v[92:95], v6 offset:1024
    v_mul_f32 v64, s52, v64
    v_cvt_pk_bf16_f32 v80, v16, v64
    ds_write_b32 v4, v80 offset:0
    v_mul_f32 v65, s52, v65
    v_cvt_pk_bf16_f32 v81, v17, v65
    ds_write_b32 v4, v81 offset:128
    v_mul_f32 v66, s52, v66
    v_cvt_pk_bf16_f32 v82, v18, v66
    ds_write_b32 v4, v82 offset:256
    s_waitcnt lgkmcnt(3)
    buffer_store_dwordx4 v[88:91], v7, s[44:47], s48 offen sc1
    s_add_u32 s48, s48, 4096
    buffer_store_dwordx4 v[92:95], v7, s[44:47], s48 offen sc1
    s_add_u32 s48, s48, 4096
    v_mul_f32 v67, s52, v67
    v_cvt_pk_bf16_f32 v83, v19, v67
    ds_write_b32 v4, v83 offset:384
    v_mul_f32 v68, s52, v68
    v_cvt_pk_bf16_f32 v84, v20, v68
    ds_write_b32 v4, v84 offset:1024
    v_mul_f32 v69, s52, v69
    v_cvt_pk_bf16_f32 v85, v21, v69
    ds_write_b32 v4, v85 offset:1152
    v_mul_f32 v70, s52, v70
    v_cvt_pk_bf16_f32 v86, v22, v70
    ds_write_b32 v4, v86 offset:1280
    v_mul_f32 v71, s52, v71
    v_cvt_pk_bf16_f32 v87, v23, v71
    ds_write_b32 v4, v87 offset:1408
    ds_read_b128 v[96:99], v6 offset:0
    ds_read_b128 v[100:103], v6 offset:1024
    s_waitcnt lgkmcnt(1)
    buffer_store_dwordx4 v[96:99], v7, s[44:47], s48 offen sc1
    s_add_u32 s48, s48, 4096
    s_waitcnt lgkmcnt(0)
    buffer_store_dwordx4 v[100:103], v7, s[44:47], s48 offen sc1
    s_add_u32 s48, s48, 4096
    v_and_b32 v72, 0x7fff7fff, v72
    v_pk_max_u16 v5, v5, v72
    v_and_b32 v73, 0x7fff7fff, v73
    v_pk_max_u16 v5, v5, v73
    v_and_b32 v74, 0x7fff7fff, v74
    v_pk_max_u16 v5, v5, v74
    v_and_b32 v75, 0x7fff7fff, v75
    v_pk_max_u16 v5, v5, v75
    v_and_b32 v76, 0x7fff7fff, v76
    v_pk_max_u16 v5, v5, v76
    v_and_b32 v77, 0x7fff7fff, v77
    v_pk_max_u16 v5, v5, v77
    v_and_b32 v78, 0x7fff7fff, v78
    v_pk_max_u16 v5, v5, v78
    v_and_b32 v79, 0x7fff7fff, v79
    v_pk_max_u16 v5, v5, v79
    v_and_b32 v80, 0x7fff7fff, v80
    v_pk_max_u16 v5, v5, v80
    v_and_b32 v81, 0x7fff7fff, v81
    v_pk_max_u16 v5, v5, v81
    v_and_b32 v82, 0x7fff7fff, v82
    v_pk_max_u16 v5, v5, v82
    v_and_b32 v83, 0x7fff7fff, v83
    v_pk_max_u16 v5, v5, v83
    v_and_b32 v84, 0x7fff7fff, v84
    v_pk_max_u16 v5, v5, v84
    v_and_b32 v85, 0x7fff7fff, v85
    v_pk_max_u16 v5, v5, v85
    v_and_b32 v86, 0x7fff7fff, v86
    v_pk_max_u16 v5, v5, v86
    v_and_b32 v87, 0x7fff7fff, v87
    v_pk_max_u16 v5, v5, v87
    v_lshlrev_b32 v6, 16, v5
    v_and_b32 v5, 0xffff0000, v5
    v_max_u32 v5, v5, v6
    s_nop 1
    v_max_u32_dpp v5, v5, v5 row_shr:1 row_mask:0xf bank_mask:0xf bound_ctrl:0
    s_nop 1
    v_max_u32_dpp v5, v5, v5 row_shr:2 row_mask:0xf bank_mask:0xf bound_ctrl:0
    s_nop 1
    v_max_u32_dpp v5, v5, v5 row_shr:4 row_mask:0xf bank_mask:0xf bound_ctrl:0
    s_nop 1
    v_max_u32_dpp v5, v5, v5 row_shr:8 row_mask:0xf bank_mask:0xf bound_ctrl:0
    s_nop 1
    v_max_u32_dpp v5, v5, v5 row_bcast:15 row_mask:0xa bank_mask:0xf
    s_nop 1
    v_max_u32_dpp v5, v5, v5 row_bcast:31 row_mask:0xc bank_mask:0xf
    v_mov_b32 v3, s30
    s_mov_b32 exec_lo, 0
    s_mov_b32 exec_hi, 0x80000000
    ds_write_b32 v3, v5
    s_mov_b64 exec, -1
    s_add_u32 s44, s24, 6543360
    s_addc_u32 s45, s25, 0
    s_mov_b32 s46, 784
    s_mov_b32 s47, 0x00020000
    s_lshl_b32 s26, s28, 1
    s_add_u32 s26, s26, s27
    s_lshl_b32 s26, s26, 2
    v_and_b32 v3, 7, v1
    v_lshlrev_b32 v3, 11, v3
    v_add_u32 v3, 65536, v3
    s_waitcnt lgkmcnt(0)
    s_barrier
    s_cmp_lg_u32 s3, 0
    s_cbranch_scc1 L1_exit
    ds_read_b32 v6, v3
    s_waitcnt lgkmcnt(0)
    v_max_u32_dpp v6, v6, v6 row_shr:1 row_mask:0xf bank_mask:0xf bound_ctrl:0
    s_nop 1
    v_max_u32_dpp v6, v6, v6 row_shr:2 row_mask:0xf bank_mask:0xf bound_ctrl:0
    s_nop 1
    v_max_u32_dpp v6, v6, v6 row_shr:4 row_mask:0xf bank_mask:0xf bound_ctrl:0
    s_mov_b64 exec, 0x80
    buffer_store_dword v6, v2, s[44:47], s26 offen sc1
    s_branch L1_exit
L1_w1b:
    s_lshl_b32 s43, s27, 1
    s_add_u32 s43, s43, s40
    s_lshl_b32 s43, s43, 14
    v_lshlrev_b32 v2, 4, v1
    s_cmp_lg_u32 s41, 0
    s_cbranch_scc1 L1_exit
    ds_read_b64_tr_b16 v[56:57], v120 offset:0
    ds_read_b64_tr_b16 v[58:59], v120 offset:1024
    ds_read_b64_tr_b16 v[60:61], v120 offset:4096
    ds_read_b64_tr_b16 v[62:63], v120 offset:5120
    ds_read_b64_tr_b16 v[64:65], v120 offset:8192
    ds_read_b64_tr_b16 v[66:67], v120 offset:9216
    ds_read_b64_tr_b16 v[68:69], v120 offset:12288
    ds_read_b64_tr_b16 v[70:71], v120 offset:13312
    ds_read_b64_tr_b16 v[72:73], v120 offset:16384
    ds_read_b64_tr_b16 v[74:75], v120 offset:17408
    ds_read_b64_tr_b16 v[76:77], v120 offset:20480
    ds_read_b64_tr_b16 v[78:79], v120 offset:21504
    ds_read_b64_tr_b16 v[80:81], v120 offset:24576
    ds_read_b64_tr_b16 v[82:83], v120 offset:25600
    ds_read_b64_tr_b16 v[84:85], v120 offset:28672
    ds_read_b64_tr_b16 v[86:87], v120 offset:29696
    ds_read_b64_tr_b16 v[88:89], v121 offset:0
    ds_read_b64_tr_b16 v[90:91], v121 offset:1024
    ds_read_b64_tr_b16 v[92:93], v121 offset:4096
    ds_read_b64_tr_b16 v[94:95], v121 offset:5120
    ds_read_b64_tr_b16 v[96:97], v121 offset:8192
    ds_read_b64_tr_b16 v[98:99], v121 offset:9216
    ds_read_b64_tr_b16 v[100:101], v121 offset:12288
    ds_read_b64_tr_b16 v[102:103], v121 offset:13312
    ds_read_b64_tr_b16 v[104:105], v121 offset:16384
    ds_read_b64_tr_b16 v[106:107], v121 offset:17408
    ds_read_b64_tr_b16 v[108:109], v121 offset:20480
    ds_read_b64_tr_b16 v[110:111], v121 offset:21504
    ds_read_b64_tr_b16 v[112:113], v121 offset:24576
    ds_read_b64_tr_b16 v[114:115], v121 offset:25600
    ds_read_b64_tr_b16 v[116:117], v121 offset:28672
    ds_read_b64_tr_b16 v[118:119], v121 offset:29696
    s_add_u32 s44, s24, 6477824
    s_addc_u32 s45, s25, 0
    s_mov_b32 s46, 65536
    s_mov_b32 s47, 0x00020000
    s_waitcnt lgkmcnt(0)
    buffer_store_dwordx4 v[56:59], v2, s[44:47], s43 offen sc1
    s_add_u32 s43, s43, 1024
    buffer_store_dwordx4 v[60:63], v2, s[44:47], s43 offen sc1
    s_add_u32 s43, s43, 1024
    buffer_store_dwordx4 v[64:67], v2, s[44:47], s43 offen sc1
    s_add_u32 s43, s43, 1024
    buffer_store_dwordx4 v[68:71], v2, s[44:47], s43 offen sc1
    s_add_u32 s43, s43, 1024
    buffer_store_dwordx4 v[72:75], v2, s[44:47], s43 offen sc1
    s_add_u32 s43, s43, 1024
    buffer_store_dwordx4 v[76:79], v2, s[44:47], s43 offen sc1
    s_add_u32 s43, s43, 1024
    buffer_store_dwordx4 v[80:83], v2, s[44:47], s43 offen sc1
    s_add_u32 s43, s43, 1024
    buffer_store_dwordx4 v[84:87], v2, s[44:47], s43 offen sc1
    s_add_u32 s43, s43, 1024
    buffer_store_dwordx4 v[88:91], v2, s[44:47], s43 offen sc1
    s_add_u32 s43, s43, 1024
    buffer_store_dwordx4 v[92:95], v2, s[44:47], s43 offen sc1
    s_add_u32 s43, s43, 1024
    buffer_store_dwordx4 v[96:99], v2, s[44:47], s43 offen sc1
    s_add_u32 s43, s43, 1024
    buffer_store_dwordx4 v[100:103], v2, s[44:47], s43 offen sc1
    s_add_u32 s43, s43, 1024
    buffer_store_dwordx4 v[104:107], v2, s[44:47], s43 offen sc1
    s_add_u32 s43, s43, 1024
    buffer_store_dwordx4 v[108:111], v2, s[44:47], s43 offen sc1
    s_add_u32 s43, s43, 1024
    buffer_store_dwordx4 v[112:115], v2, s[44:47], s43 offen sc1
    s_add_u32 s43, s43, 1024
    buffer_store_dwordx4 v[116:119], v2, s[44:47], s43 offen sc1
    s_add_u32 s43, s43, 1024
    s_branch L1_exit
L1_part:
    s_sub_u32 s56, s2, 211
    v_lshlrev_b32 v2, 2, v0
    v_mov_b32 v3, 0
    ds_write_b32 v2, v3 offset:40960
    ds_write_b32 v2, v3 offset:43008
    v_mov_b32 v60, 0
    v_mov_b32 v61, 1
    s_mul_i32 s26, s56, 6400
    s_add_u32 s27, s26, 6400
    s_mov_b32 s58, s26
    s_mov_b32 s59, s27
    s_lshl_b32 s52, s26, 1
    s_lshl_b32 s53, s27, 1
    v_lshlrev_b32 v3, 4, v0
    v_lshlrev_b32 v20, 5, v0
    v_cmp_gt_u32 vcc, 400, v0
    s_waitcnt lgkmcnt(0)
    s_mov_b32 s28, s10
    s_mov_b32 s29, s11
    s_mov_b32 s30, 1600000
    s_mov_b32 s31, 0x00020000
    s_mov_b32 s32, s8
    s_mov_b32 s33, s9
    s_mov_b32 s34, 1600000
    s_mov_b32 s35, 0x00020000
    s_mov_b32 s36, s6
    s_mov_b32 s37, s7
    s_mov_b32 s38, 3200000
    s_mov_b32 s39, 0x00020000
    s_and_saveexec_b64 s[54:55], vcc
    s_mov_b64 s[54:55], exec
    s_cbranch_execz L1_p1
    buffer_load_dwordx4 v[4:7], v3, s[28:31], s26 offen
L1_p1:
    s_mov_b64 exec, -1
    s_mul_i32 s26, s56, 19200
    s_add_u32 s26, s26, 6802432
    s_add_u32 s40, s24, s26
    s_addc_u32 s41, s25, 0
    s_mov_b32 s42, 19200
    s_mov_b32 s43, 0x00020000
    s_add_u32 s44, s24, 6546432
    s_addc_u32 s45, s25, 0
    s_mov_b32 s46, 256000
    s_mov_b32 s47, 0x00020000
    s_add_u32 s48, s24, 6544384
    s_addc_u32 s49, s25, 0
    s_mov_b32 s50, 1000
    s_mov_b32 s51, 0x00020000
    s_setprio 2
    s_barrier
    s_mov_b64 exec, s[54:55]
    s_cbranch_execz L1_p2
    s_waitcnt vmcnt(0)
    buffer_load_dwordx4 v[12:15], v3, s[32:35], s58 offen
    buffer_load_dwordx4 v[24:27], v20, s[36:39], s52 offen
    buffer_load_dwordx4 v[28:31], v20, s[36:39], s52 offen offset:16
    v_mul_u32_u24 v21, 10700, v4
    v_lshrrev_b32 v21, 19, v21
    v_lshlrev_b32 v40, 2, v21
    ds_add_rtn_u32 v48, v40, v61 offset:40960
    v_mul_u32_u24 v21, 49, v21
    v_sub_u32 v4, v4, v21
    v_mul_u32_u24 v21, 10700, v5
    v_lshrrev_b32 v21, 19, v21
    v_lshlrev_b32 v41, 2, v21
    ds_add_rtn_u32 v49, v41, v61 offset:40960
    v_mul_u32_u24 v21, 49, v21
    v_sub_u32 v5, v5, v21
    v_mul_u32_u24 v21, 10700, v6
    v_lshrrev_b32 v21, 19, v21
    v_lshlrev_b32 v42, 2, v21
    ds_add_rtn_u32 v50, v42, v61 offset:40960
    v_mul_u32_u24 v21, 49, v21
    v_sub_u32 v6, v6, v21
    v_mul_u32_u24 v21, 10700, v7
    v_lshrrev_b32 v21, 19, v21
    v_lshlrev_b32 v43, 2, v21
    ds_add_rtn_u32 v51, v43, v61 offset:40960
    v_mul_u32_u24 v21, 49, v21
    v_sub_u32 v7, v7, v21
L1_p2:
    s_mov_b64 exec, -1
    v_lshlrev_b32 v2, 4, v1
    s_waitcnt lgkmcnt(0)
    s_barrier
    ds_read_b128 v[64:67], v2 offset:40960
    s_waitcnt lgkmcnt(0)
    v_add_u32 v68, v64, v65
    v_add_u32 v69, v68, v66
    v_add_u32 v70, v69, v67
    v_mov_b32 v71, v70
    s_nop 1
    v_add_u32_dpp v71, v71, v71 row_shr:1 row_mask:0xf bank_mask:0xf bound_ctrl:0
    s_nop 1
    v_add_u32_dpp v71, v71, v71 row_shr:2 row_mask:0xf bank_mask:0xf bound_ctrl:0
    s_nop 1
    v_add_u32_dpp v71, v71, v71 row_shr:4 row_mask:0xf bank_mask:0xf bound_ctrl:0
    s_nop 1
    v_add_u32_dpp v71, v71, v71 row_shr:8 row_mask:0xf bank_mask:0xf bound_ctrl:0
    s_nop 1
    v_add_u32_dpp v71, v71, v71 row_bcast:15 row_mask:0xa bank_mask:0xf
    s_nop 1
    v_add_u32_dpp v71, v71, v71 row_bcast:31 row_mask:0xc bank_mask:0xf
    v_sub_u32 v56, v71, v70
    v_add_u32 v57, v56, v64
    v_add_u32 v58, v56, v68
    v_add_u32 v59, v56, v69
    ds_write_b128 v2, v[56:59] offset:41984
    s_mov_b64 exec, s[54:55]
    s_cbranch_execz L1_p4
    ds_read_b32 v40, v40 offset:41984
    ds_read_b32 v41, v41 offset:41984
    ds_read_b32 v42, v42 offset:41984
    ds_read_b32 v43, v43 offset:41984
    s_waitcnt vmcnt(2)
    v_add_u32 v21, 10134, v12
    v_lshl_or_b32 v12, v4, 18, v12
    v_lshrrev_b32 v21, 14, v21
    v_lshl_or_b32 v12, v21, 24, v12
    v_add_u32 v21, 10134, v13
    v_lshl_or_b32 v13, v5, 18, v13
    v_lshrrev_b32 v21, 14, v21
    v_lshl_or_b32 v13, v21, 24, v13
    v_add_u32 v21, 10134, v14
    v_lshl_or_b32 v14, v6, 18, v14
    v_lshrrev_b32 v21, 14, v21
    v_lshl_or_b32 v14, v21, 24, v14
    v_add_u32 v21, 10134, v15
    v_lshl_or_b32 v15, v7, 18, v15
    v_lshrrev_b32 v21, 14, v21
    v_lshl_or_b32 v15, v21, 24, v15
    s_waitcnt vmcnt(0)
    s_waitcnt lgkmcnt(3)
    v_add_u32 v40, v40, v48
    v_mul_u32_u24 v40, 12, v40
    ds_write2_b32 v40, v24, v25 offset0:0 offset1:1
    ds_write_b32 v40, v12 offset:8
    s_waitcnt lgkmcnt(4)
    v_add_u32 v41, v41, v49
    v_mul_u32_u24 v41, 12, v41
    ds_write2_b32 v41, v26, v27 offset0:0 offset1:1
    ds_write_b32 v41, v13 offset:8
    s_waitcnt lgkmcnt(5)
    v_add_u32 v42, v42, v50
    v_mul_u32_u24 v42, 12, v42
    ds_write2_b32 v42, v28, v29 offset0:0 offset1:1
    ds_write_b32 v42, v14 offset:8
    s_waitcnt lgkmcnt(6)
    v_add_u32 v43, v43, v51
    v_mul_u32_u24 v43, 12, v43
    ds_write2_b32 v43, v30, v31 offset0:0 offset1:1
    ds_write_b32 v43, v15 offset:8
L1_p4:
    s_mov_b64 exec, -1
    s_cmp_lg_u32 s3, 7
    s_cbranch_scc1 L1_p3
    v_lshl_or_b32 v64, v64, 16, v56
    v_lshl_or_b32 v65, v65, 16, v57
    v_lshl_or_b32 v66, v66, 16, v58
    v_lshl_or_b32 v67, v67, 16, v59
    v_mul_u32_u24 v2, 4000, v1
    s_lshl_b32 s26, s56, 4
    buffer_store_dwordx4 v[64:67], v2, s[44:47], s26 offen sc1
L1_p3:
    s_waitcnt lgkmcnt(0)
    s_barrier
    ds_read_b128 v[72:75], v3 offset:0
    ds_read_b128 v[76:79], v3 offset:8192
    ds_read_b128 v[80:83], v3 offset:16384
    s_mov_b32 s26, 0
    s_waitcnt lgkmcnt(2)
    buffer_store_dwordx4 v[72:75], v3, s[40:43], s26 offen sc1
    s_mov_b32 s26, 8192
    s_waitcnt lgkmcnt(1)
    buffer_store_dwordx4 v[76:79], v3, s[40:43], s26 offen sc1
    s_mov_b32 s26, 16384
    s_waitcnt lgkmcnt(0)
    buffer_store_dwordx4 v[80:83], v3, s[40:43], s26 offen sc1
    s_mov_b64 exec, s[54:55]
    v_dot2_f32_bf16 v4, v24, v24, 0
    v_dot2_f32_bf16 v5, v26, v26, 0
    v_dot2_f32_bf16 v6, v28, v28, 0
    v_dot2_f32_bf16 v7, v30, v30, 0
    v_dot2_f32_bf16 v4, v25, v25, v4
    v_dot2_f32_bf16 v5, v27, v27, v5
    v_dot2_f32_bf16 v6, v29, v29, v6
    v_dot2_f32_bf16 v7, v31, v31, v7
    s_nop 2
    v_max3_u32 v60, v60, v4, v5
    v_max3_u32 v60, v60, v6, v7
    s_mov_b64 exec, -1
    s_nop 0
    v_max_u32_dpp v60, v60, v60 row_shr:1 row_mask:0xf bank_mask:0xf bound_ctrl:0
    s_nop 1
    v_max_u32_dpp v60, v60, v60 row_shr:2 row_mask:0xf bank_mask:0xf bound_ctrl:0
    s_nop 1
    v_max_u32_dpp v60, v60, v60 row_shr:4 row_mask:0xf bank_mask:0xf bound_ctrl:0
    s_nop 1
    v_max_u32_dpp v60, v60, v60 row_shr:8 row_mask:0xf bank_mask:0xf bound_ctrl:0
    s_nop 1
    v_max_u32_dpp v60, v60, v60 row_bcast:15 row_mask:0xa bank_mask:0xf
    s_nop 1
    v_max_u32_dpp v60, v60, v60 row_bcast:31 row_mask:0xc bank_mask:0xf
    v_mov_b32 v62, 0
    s_mov_b32 exec_lo, 0
    s_mov_b32 exec_hi, 0x80000000
    ds_max_u32 v62, v60 offset:43008
    s_mov_b64 exec, -1
    s_waitcnt lgkmcnt(0)
    s_barrier
    ds_read_b32 v30, v62 offset:43008
    s_lshl_b32 s26, s56, 2
    v_cmp_eq_u32 vcc, 0, v0
    s_nop 0
    s_and_saveexec_b64 s[54:55], vcc
    s_cbranch_execz L1_exit
    s_waitcnt lgkmcnt(0)
    buffer_store_dword v30, v62, s[48:51], s26 offen sc1
    s_branch L1_exit
L1_w2:
    v_lshlrev_b32 v2, 4, v1
    s_lshl_b32 s29, s3, 13
    s_mov_b32 m0, s29
    v_mov_b32 v20, 0
    v_mov_b32 v21, 65536
    ds_write_b32 v21, v20
    v_and_b32 v11, 1, v1
    v_lshlrev_b32 v11, 5, v11
    v_bfe_u32 v12, v1, 1, 4
    v_add_u32 v11, v11, v12
    v_lshlrev_b32 v11, 1, v11
    v_lshrrev_b32 v12, 5, v1
    v_lshl_add_u32 v11, v12, 10, v11
    s_lshr_b32 s40, s3, 1
    s_lshl_b32 s40, s40, 7
    s_and_b32 s41, s3, 1
    s_lshl_b32 s41, s41, 5
    s_add_u32 s40, s40, s41
    s_add_u32 s40, s40, 131072
    s_waitcnt lgkmcnt(0)
    s_mov_b32 s32, s16
    s_mov_b32 s33, s17
    s_mov_b32 s34, 65536
    s_mov_b32 s35, 0x00020000
    s_mov_b32 s36, s12
    s_mov_b32 s37, s13
    s_mov_b32 s38, 133120
    s_mov_b32 s39, 0x00020000
    s_mov_b32 s60, s14
    s_mov_b32 s61, s15
    s_mov_b32 s62, 512
    s_mov_b32 s63, 0x00020000
    v_and_b32 v17, 31, v1
    v_lshlrev_b32 v17, 1, v17
    s_lshl_b32 s41, s3, 7
    buffer_load_ushort v18, v17, s[60:63], s41 offen
    buffer_load_ushort v19, v17, s[60:63], s41 offen offset:64
    buffer_load_ushort v8, v11, s[36:39], s40 offen
    buffer_load_ushort v9, v11, s[36:39], s40 offen offset:512
    buffer_load_dwordx4 v2, s[32:35], s29 offen lds
    s_add_u32 m0, m0, 1024
    s_add_u32 s29, s29, 1024
    buffer_load_dwordx4 v2, s[32:35], s29 offen lds
    s_add_u32 m0, m0, 1024
    s_add_u32 s29, s29, 1024
    buffer_load_dwordx4 v2, s[32:35], s29 offen lds
    s_add_u32 m0, m0, 1024
    s_add_u32 s29, s29, 1024
    buffer_load_dwordx4 v2, s[32:35], s29 offen lds
    s_add_u32 m0, m0, 1024
    s_add_u32 s29, s29, 1024
    buffer_load_dwordx4 v2, s[32:35], s29 offen lds
    s_add_u32 m0, m0, 1024
    s_add_u32 s29, s29, 1024
    buffer_load_dwordx4 v2, s[32:35], s29 offen lds
    s_add_u32 m0, m0, 1024
    s_add_u32 s29, s29, 1024
    buffer_load_dwordx4 v2, s[32:35], s29 offen lds
    s_add_u32 m0, m0, 1024
    s_add_u32 s29, s29, 1024
    buffer_load_dwordx4 v2, s[32:35], s29 offen lds
    s_and_b32 s40, s3, 3
    s_lshr_b32 s41, s3, 2
    v_bfe_u32 v5, v1, 2, 1
    v_lshlrev_b32 v5, 5, v5
    v_bfe_u32 v6, v1, 3, 1
    v_add_u32 v5, v5, v6
    v_lshrrev_b32 v6, 5, v1
    v_lshl_add_u32 v5, v6, 2, v5
    v_lshlrev_b32 v5, 8, v5
    v_bfe_u32 v6, v1, 4, 1
    v_lshl_add_u32 v5, v6, 5, v5
    v_and_b32 v6, 3, v1
    v_lshl_add_u32 v5, v6, 3, v5
    s_lshl_b32 s42, s40, 6
    s_lshl_b32 s43, s41, 15
    s_add_u32 s42, s42, s43
    v_add_u32 v5, s42, v5
    s_lshl_b32 s43, s40, 14
    s_lshl_b32 s42, s41, 13
    s_add_u32 s43, s43, s42
    s_mov_b32 s52, 3216550459
    s_lshl_b32 s42, s3, 9
    v_lshlrev_b32 v3, 3, v1
    s_add_u32 s44, s24, 6404096
    s_addc_u32 s45, s25, 0
    s_mov_b32 s46, 65536
    s_mov_b32 s47, 0x00020000
    s_add_u32 s48, s24, 6469632
    s_addc_u32 s49, s25, 0
    s_mov_b32 s50, 4096
    s_mov_b32 s51, 0x00020000
    s_add_u32 s56, s24, 6545408
    s_addc_u32 s57, s25, 0
    s_mov_b32 s58, 4
    s_mov_b32 s59, 0x00020000
    s_waitcnt vmcnt(8)
    v_lshlrev_b32 v8, 16, v8
    v_lshlrev_b32 v9, 16, v9
    v_mul_f32 v8, s52, v8
    v_mul_f32 v9, s52, v9
    v_cvt_pk_bf16_f32 v15, v8, v9
    v_mul_f32 v16, v8, v8
    v_fmac_f32 v16, v9, v9
    v_lshlrev_b32 v12, 16, v15
    v_and_b32 v13, 0xffff0000, v15
    v_sub_f32 v8, v8, v12
    v_sub_f32 v9, v9, v13
    v_cvt_pk_bf16_f32 v14, v8, v9
    buffer_store_dwordx2 v[14:15], v3, s[48:51], s42 offen sc1
    v_lshlrev_b32 v18, 16, v18
    v_lshlrev_b32 v19, 16, v19
    v_mul_f32 v18, s52, v18
    v_mul_f32 v19, s52, v19
    v_lshlrev_b32 v17, 2, v17
    s_lshl_b32 s41, s3, 8
    s_add_u32 s60, s24, 6473728
    s_addc_u32 s61, s25, 0
    s_mov_b32 s62, 1024
    s_mov_b32 s63, 0x00020000
    s_add_u32 s64, s24, 6400000
    s_addc_u32 s65, s25, 0
    s_mov_b32 s66, 1024
    s_mov_b32 s67, 0x00020000
    buffer_store_dwordx2 v[18:19], v17, s[60:63], s41 offen sc1
    v_mov_b32 v22, 0x41c041c0
    v_mov_b32 v23, 0x7f7f7f7f
    v_cmp_gt_u32 vcc, 128, v0
    v_lshlrev_b32 v24, 2, v0
    s_nop 0
    v_cndmask_b32 v22, v23, v22, vcc
    buffer_store_dword v22, v24, s[64:67], 0 offen sc1
    v_mov_b32 v12, v16
    s_nop 1
    v_permlane32_swap_b32 v12, v16
    v_add_f32 v16, v12, v16
    s_nop 1
    v_max_u32_dpp v16, v16, v16 row_shr:1 row_mask:0xf bank_mask:0xf bound_ctrl:0
    s_nop 1
    v_max_u32_dpp v16, v16, v16 row_shr:2 row_mask:0xf bank_mask:0xf bound_ctrl:0
    s_nop 1
    v_max_u32_dpp v16, v16, v16 row_shr:4 row_mask:0xf bank_mask:0xf bound_ctrl:0
    s_nop 1
    v_max_u32_dpp v16, v16, v16 row_shr:8 row_mask:0xf bank_mask:0xf bound_ctrl:0
    s_nop 1
    v_max_u32_dpp v16, v16, v16 row_bcast:15 row_mask:0xa bank_mask:0xf
    s_nop 1
    v_max_u32_dpp v16, v16, v16 row_bcast:31 row_mask:0xc bank_mask:0xf
    s_waitcnt vmcnt(0)
    s_barrier
    s_mov_b32 exec_lo, 0
    s_mov_b32 exec_hi, 0x80000000
    ds_max_u32 v21, v16
    s_mov_b64 exec, -1
    ds_read_b64_tr_b16 v[56:57], v5 offset:0
    ds_read_b64_tr_b16 v[58:59], v5 offset:512
    ds_read_b64_tr_b16 v[60:61], v5 offset:2048
    ds_read_b64_tr_b16 v[62:63], v5 offset:2560
    ds_read_b64_tr_b16 v[64:65], v5 offset:4096
    ds_read_b64_tr_b16 v[66:67], v5 offset:4608
    ds_read_b64_tr_b16 v[68:69], v5 offset:6144
    ds_read_b64_tr_b16 v[70:71], v5 offset:6656
    ds_read_b64_tr_b16 v[72:73], v5 offset:16384
    ds_read_b64_tr_b16 v[74:75], v5 offset:16896
    ds_read_b64_tr_b16 v[76:77], v5 offset:18432
    ds_read_b64_tr_b16 v[78:79], v5 offset:18944
    ds_read_b64_tr_b16 v[80:81], v5 offset:20480
    ds_read_b64_tr_b16 v[82:83], v5 offset:20992
    ds_read_b64_tr_b16 v[84:85], v5 offset:22528
    ds_read_b64_tr_b16 v[86:87], v5 offset:23040
    s_waitcnt lgkmcnt(0)
    s_barrier
    ds_read_b32 v16, v21
    buffer_store_dwordx4 v[56:59], v2, s[44:47], s43 offen sc1
    s_add_u32 s43, s43, 1024
    buffer_store_dwordx4 v[60:63], v2, s[44:47], s43 offen sc1
    s_add_u32 s43, s43, 1024
    buffer_store_dwordx4 v[64:67], v2, s[44:47], s43 offen sc1
    s_add_u32 s43, s43, 1024
    buffer_store_dwordx4 v[68:71], v2, s[44:47], s43 offen sc1
    s_add_u32 s43, s43, 1024
    buffer_store_dwordx4 v[72:75], v2, s[44:47], s43 offen sc1
    s_add_u32 s43, s43, 1024
    buffer_store_dwordx4 v[76:79], v2, s[44:47], s43 offen sc1
    s_add_u32 s43, s43, 1024
    buffer_store_dwordx4 v[80:83], v2, s[44:47], s43 offen sc1
    s_add_u32 s43, s43, 1024
    buffer_store_dwordx4 v[84:87], v2, s[44:47], s43 offen sc1
    s_add_u32 s43, s43, 1024
    s_add_u32 s48, s24, 6545384
    s_addc_u32 s49, s25, 0
    s_mov_b32 s50, 16
    s_mov_b32 s51, 0x00020000
    v_lshlrev_b32 v17, 2, v1
    buffer_store_dword v20, v17, s[48:51], 0 offen sc1
    s_waitcnt lgkmcnt(0)
    buffer_store_dword v16, v3, s[56:59], 0 offen sc1
L1_exit:
L1_exit2:
    s_endpgm
.globl k2_kernel
.p2align 8
.type k2_kernel,@function
k2_kernel:
    s_cmp_ge_u32 s2, 256
    s_cbranch_scc1 L2_exit2
    s_load_dwordx16 s[4:19], s[0:1], 0
    s_load_dwordx4 s[20:23], s[0:1], 64
    s_load_dwordx2 s[24:25], s[0:1], 80
    v_and_b32 v125, 63, v0
    v_lshrrev_b32 v2, 6, v0
    s_and_b32 s87, s2, 7
    v_readfirstlane_b32 s3, v2
    s_lshl_b32 s87, s87, 5
    s_lshr_b32 s28, s2, 3
    s_add_u32 s87, s87, s28
    s_mul_i32 s93, s87, 49
    s_mov_b32 s80, 0
    s_mov_b32 s81, 24
    s_mov_b32 s82, 15
    s_mov_b32 s83, 0
    s_mov_b32 s86, 1
    s_mov_b32 s92, 0
    s_and_b32 s26, s3, 3
    s_lshr_b32 s27, s3, 2
    v_lshlrev_b32 v161, 4, v125
    s_cmp_eq_u32 s27, 2
    s_cbranch_scc0 L2_M
    s_cmp_ge_u32 s2, 32
    s_cbranch_scc1 L_pe2
    s_getpc_b64 s[40:41]
L_pc2:
    s_sub_u32 s40, s40, L_pc2-k2_kernel
    s_subb_u32 s41, s41, 0
    s_mul_i32 s42, s26, 4608
    v_min_u32 v10, 35, v125
    v_lshl_add_u32 v10, v10, 7, s42
    v_min_u32 v10, L2_last-k2_kernel-4, v10
    v_mov_b32 v11, s41
    v_add_co_u32 v10, vcc, s40, v10
    s_nop 1
    v_addc_co_u32 v11, vcc, 0, v11, vcc
    global_load_dword v167, v[10:11], off
L_pe2:
    s_branch L2_H
L2_M:
    s_lshr_b32 s96, s87, 2
    s_mul_i32 s96, s96, 4000
    s_and_b32 s97, s87, 3
    s_lshl_b32 s97, s97, 2
    s_add_u32 s96, s96, 6546432
    s_lshl_b32 s91, s3, 13
    s_add_u32 s91, s91, 91136
    v_mov_b32 v148, -1
    v_mov_b32 v149, 0
    v_mov_b32 v150, -1
    v_mov_b32 v151, 0
    v_mov_b32 v152, -1
    v_mov_b32 v153, 0
    v_mov_b32 v154, -1
    v_mov_b32 v155, 0
    s_lshl_b32 s98, s3, 7
    s_add_u32 s98, s98, s97
    s_waitcnt lgkmcnt(0)
    s_mov_b32 s6, s98
    s_add_u32 s8, s24, s96
    s_addc_u32 s9, s25, 0
    s_mov_b32 s10, 4000
    s_mov_b32 s11, 0x00020000
L2_batch:
    v_lshrrev_b32 v113, 3, v125
    v_lshl_add_u32 v9, v113, 4, s6
    buffer_load_dword v116, v9, s[8:11], 0 offen offset:0
    buffer_load_dword v117, v9, s[8:11], 0 offen offset:1024
    buffer_load_dword v118, v9, s[8:11], 0 offen offset:2048
    buffer_load_dword v119, v9, s[8:11], 0 offen offset:3072
    s_add_u32 s32, s24, 6802432
    s_addc_u32 s33, s25, 0
    s_mov_b32 s34, 4800000
    s_mov_b32 s35, 0x00020000
    s_mov_b32 s36, s24
    s_mov_b32 s37, s25
    s_or_b32 s37, s37, 33554432
    s_mov_b32 s38, 12502
    s_mov_b32 s39, 0x00020000
    s_and_b32 s96, s86, s27
    s_cbranch_scc1 L2_stat
L2_ld:
    v_and_b32 v112, 7, v125
    v_add_u32 v112, s80, v112
    s_lshl_b32 s96, s3, 3
    v_add_u32 v113, s96, v113
    s_add_u32 s96, s80, s81
    v_mul_u32_u24 v113, 19200, v113
    s_waitcnt vmcnt(0)
    v_lshrrev_b32 v104, 16, v116
    s_bitcmp1_b32 s82, 0
    s_cselect_b32 s98, s96, 0
    v_min_u32 v104, s98, v104
    v_and_b32 v114, 0xffff, v116
    v_add_u32 v114, v114, v112
    v_mad_u32_u24 v108, v114, 12, v113
    v_add_u32 v113, 1228800, v113
    v_lshrrev_b32 v105, 16, v117
    s_bitcmp1_b32 s82, 1
    s_cselect_b32 s98, s96, 0
    v_min_u32 v105, s98, v105
    v_and_b32 v114, 0xffff, v117
    v_add_u32 v114, v114, v112
    v_mad_u32_u24 v109, v114, 12, v113
    v_add_u32 v113, 1228800, v113
    v_lshrrev_b32 v106, 16, v118
    s_bitcmp1_b32 s82, 2
    s_cselect_b32 s98, s96, 0
    v_min_u32 v106, s98, v106
    v_and_b32 v114, 0xffff, v118
    v_add_u32 v114, v114, v112
    v_mad_u32_u24 v110, v114, 12, v113
    v_add_u32 v113, 1228800, v113
    v_lshrrev_b32 v107, 16, v119
    s_bitcmp1_b32 s82, 3
    s_cselect_b32 s98, s96, 0
    v_min_u32 v107, s98, v107
    v_and_b32 v114, 0xffff, v119
    v_add_u32 v114, v114, v112
    v_mad_u32_u24 v111, v114, 12, v113
    v_cmp_lt_u32 s[56:57], v112, v104
    v_cmp_lt_u32 s[58:59], v112, v105
    v_cmp_lt_u32 s[60:61], v112, v106
    v_cmp_lt_u32 s[62:63], v112, v107
    s_mov_b64 exec, s[56:57]
    s_cbranch_execz L2_r0
    buffer_load_dwordx3 v[0:2], v108, s[32:35], 0 offen offset:0
L2_r0:
    s_mov_b64 exec, s[58:59]
    s_cbranch_execz L2_r1
    buffer_load_dwordx3 v[4:6], v109, s[32:35], 0 offen offset:0
L2_r1:
    s_mov_b64 exec, s[60:61]
    s_cbranch_execz L2_r2
    buffer_load_dwordx3 v[8:10], v110, s[32:35], 0 offen offset:0
L2_r2:
    s_mov_b64 exec, s[62:63]
    s_cbranch_execz L2_r3
    buffer_load_dwordx3 v[12:14], v111, s[32:35], 0 offen offset:0
L2_r3:
    s_mov_b64 exec, -1
    v_add_u32 v112, 8, v112
    v_cmp_lt_u32 s[64:65], v112, v104
    v_cmp_lt_u32 s[66:67], v112, v105
    v_cmp_lt_u32 s[68:69], v112, v106
    v_cmp_lt_u32 s[70:71], v112, v107
    s_mov_b64 exec, s[64:65]
    s_cbranch_execz L2_r4
    buffer_load_dwordx3 v[16:18], v108, s[32:35], 0 offen offset:96
L2_r4:
    s_mov_b64 exec, s[66:67]
    s_cbranch_execz L2_r5
    buffer_load_dwordx3 v[20:22], v109, s[32:35], 0 offen offset:96
L2_r5:
    s_mov_b64 exec, s[68:69]
    s_cbranch_execz L2_r6
    buffer_load_dwordx3 v[24:26], v110, s[32:35], 0 offen offset:96
L2_r6:
    s_mov_b64 exec, s[70:71]
    s_cbranch_execz L2_r7
    buffer_load_dwordx3 v[28:30], v111, s[32:35], 0 offen offset:96
L2_r7:
    s_mov_b64 exec, -1
    v_add_u32 v112, 8, v112
    v_cmp_lt_u32 s[72:73], v112, v104
    v_cmp_lt_u32 s[74:75], v112, v105
    v_cmp_lt_u32 s[76:77], v112, v106
    v_cmp_lt_u32 s[78:79], v112, v107
    s_or_b64 s[96:97], s[72:73], s[74:75]
    s_or_b64 s[98:99], s[76:77], s[78:79]
    s_or_b64 s[96:97], s[96:97], s[98:99]
    s_cselect_b32 s1, 1, 0
    s_cbranch_scc1 L2_x0
L2_x0_r:
    s_cmp_eq_u32 s86, 0
    s_cbranch_scc1 L2_rank0
    v_lshrrev_b32 v104, 16, v116
    v_lshrrev_b32 v105, 16, v117
    v_lshrrev_b32 v106, 16, v118
    v_lshrrev_b32 v107, 16, v119
    v_max3_u32 v104, v104, v105, v106
    v_max_u32 v115, v104, v107
    s_lshl_b32 s96, s26, 10
    v_lshlrev_b32 v114, 3, v125
    s_add_u32 s44, s24, 6469632
    s_addc_u32 s45, s25, 0
    s_mov_b32 s46, 4096
    s_mov_b32 s47, 0x00020000
    buffer_load_dwordx2 v[138:139], v114, s[44:47], s96 offen
    buffer_load_dwordx2 v[142:143], v114, s[44:47], s96 offen offset:512
    s_cmp_lg_u32 s27, 0
    s_cbranch_scc1 L2_wrec
L2_stat:
    v_mov_b32 v64, 0
    v_mov_b32 v65, 0
    v_mov_b32 v66, 0
    v_mov_b32 v67, 0
    v_mov_b32 v68, 0
    v_mov_b32 v69, 0
    v_mov_b32 v70, 0
    v_mov_b32 v71, 0
    v_mov_b32 v72, 0
    v_mov_b32 v73, 0
    v_mov_b32 v74, 0
    v_mov_b32 v75, 0
    v_mov_b32 v76, 0
    v_mov_b32 v77, 0
    v_mov_b32 v78, 0
    v_mov_b32 v79, 0
    v_mov_b32 v80, 0
    v_mov_b32 v81, 0
    v_mov_b32 v82, 0
    v_mov_b32 v83, 0
    v_mov_b32 v84, 0
    v_mov_b32 v85, 0
    v_mov_b32 v86, 0
    v_mov_b32 v87, 0
    v_mov_b32 v88, 0
    v_mov_b32 v89, 0
    v_mov_b32 v90, 0
    v_mov_b32 v91, 0
    v_mov_b32 v92, 0
    v_mov_b32 v93, 0
    v_mov_b32 v94, 0
    v_mov_b32 v95, 0
    v_and_b32 v96, 31, v125
    v_lshrrev_b32 v97, 5, v125
    v_bfe_u32 v100, v96, 1, 3
    v_lshlrev_b32 v100, 4, v100
    v_lshl_add_u32 v100, v96, 7, v100
    v_lshl_add_u32 v100, v97, 3, v100
    v_add_u32 v162, s91, v100
    v_bfe_u32 v100, v96, 2, 1
    v_lshrrev_b32 v101, 4, v96
    v_and_b32 v102, 1, v96
    v_xor_b32 v103, v100, v97
    v_lshl_or_b32 v103, v103, 1, v102
    v_cmp_eq_u32 s[94:95], 0, v103
    v_cmp_eq_u32 s[96:97], 1, v103
    v_lshlrev_b32 v103, 4, v101
    v_mov_b32 v98, 0x3f80
    v_lshlrev_b32 v98, v103, v98
    v_cndmask_b32 v128, 0, v98, s[94:95]
    v_cndmask_b32 v129, 0, v98, s[96:97]
    v_cndmask_b32 v132, 0, v98, s[94:95]
    v_cndmask_b32 v133, 0, v98, s[96:97]
    v_lshlrev_b32 v100, 4, v100
    v_lshl_or_b32 v100, v102, 3, v100
    v_lshl_or_b32 v100, v101, 2, v100
    v_bfe_u32 v103, v96, 3, 1
    v_lshl_or_b32 v100, v103, 1, v100
    v_bfe_u32 v104, v96, 1, 1
    v_or_b32 v100, v100, v104
    v_lshlrev_b32 v126, 3, v100
    v_lshl_add_u32 v126, v97, 2, v126
    v_lshrrev_b32 v101, 4, v100
    v_bfe_u32 v102, v100, 2, 1
    v_lshl_or_b32 v101, v101, 1, v102
    v_and_b32 v102, 3, v100
    v_lshlrev_b32 v103, 2, v101
    v_lshlrev_b32 v124, v103, v102
    v_bfe_u32 v102, v100, 3, 1
    v_xor_b32 v102, v102, v97
    v_lshl_or_b32 v101, v102, 2, v101
    v_mov_b32 v98, 0x3f80
    v_cmp_eq_u32 s[94:95], 0, v101
    s_nop 0
    v_cmp_eq_u32 s[96:97], 1, v101
    v_cndmask_b32 v120, 0, v98, s[94:95]
    v_cmp_eq_u32 s[98:99], 2, v101
    v_cndmask_b32 v121, 0, v98, s[96:97]
    v_cmp_eq_u32 s[94:95], 3, v101
    v_cndmask_b32 v122, 0, v98, s[98:99]
    v_bfe_u32 v100, v125, 2, 2
    v_cndmask_b32 v123, 0, v98, s[94:95]
    v_lshl_add_u32 v101, v97, 4, v100
    v_lshlrev_b32 v101, 7, v101
    v_lshrrev_b32 v100, 1, v100
    v_lshl_add_u32 v101, v100, 6, v101
    v_bfe_u32 v100, v125, 4, 1
    v_lshl_add_u32 v101, v100, 5, v101
    v_and_b32 v102, 3, v125
    v_lshl_add_u32 v101, v102, 3, v101
    v_add_u32 v159, s91, v101
    v_xor_b32 v160, 64, v159
    v_lshlrev_b32 v101, 2, v100
    v_and_b32 v102, 7, v125
    v_xor_b32 v101, v101, v102
    s_lshl_b32 s96, s26, 7
    v_lshl_add_u32 v149, v101, 4, s96
    v_xor_b32 v151, 0, v149
    v_mov_b32 v153, v149
    v_mov_b32 v155, v151
    v_bfe_u32 v100, v125, 4, 1
    v_lshlrev_b32 v100, 5, v100
    v_and_b32 v102, 3, v125
    v_lshl_add_u32 v100, v102, 3, v100
    v_add_u32 v158, s96, v100
    v_bfe_u32 v100, v125, 2, 2
    v_lshl_add_u32 v127, v97, 2, v100
    v_lshlrev_b32 v127, 2, v127
    s_cmp_lg_u32 s27, 0
    s_cbranch_scc1 L2_ld
L2_wrec:
    v_max_u32_dpp v115, v115, v115 row_shr:1 row_mask:0xf bank_mask:0xf bound_ctrl:0
    s_nop 1
    v_max_u32_dpp v115, v115, v115 row_shr:2 row_mask:0xf bank_mask:0xf bound_ctrl:0
    s_nop 1
    v_max_u32_dpp v115, v115, v115 row_shr:4 row_mask:0xf bank_mask:0xf bound_ctrl:0
    s_nop 1
    v_max_u32_dpp v115, v115, v115 row_shr:8 row_mask:0xf bank_mask:0xf bound_ctrl:0
    s_nop 1
    v_max_u32_dpp v115, v115, v115 row_bcast:15 row_mask:0xa bank_mask:0xf
    s_nop 1
    v_max_u32_dpp v115, v115, v115 row_bcast:31 row_mask:0xc bank_mask:0xf
    s_waitcnt vmcnt(2)
    s_branch L2_rank2
L2_rank0:
    s_waitcnt vmcnt(0)
L2_rank2:
    v_mov_b32 v62, 1
    v_mov_b32 v63, 0
    s_barrier
    s_mov_b64 exec, s[56:57]
    v_lshrrev_b32 v96, 14, v2
    ds_add_rtn_u32 v3, v96, v62 offset:12544
    s_mov_b64 exec, s[58:59]
    v_lshrrev_b32 v97, 14, v6
    ds_add_rtn_u32 v7, v97, v62 offset:12544
    s_mov_b64 exec, s[60:61]
    v_lshrrev_b32 v98, 14, v10
    ds_add_rtn_u32 v11, v98, v62 offset:12544
    s_mov_b64 exec, s[62:63]
    v_lshrrev_b32 v99, 14, v14
    ds_add_rtn_u32 v15, v99, v62 offset:12544
    s_mov_b64 exec, s[64:65]
    v_lshrrev_b32 v100, 14, v18
    ds_add_rtn_u32 v19, v100, v62 offset:12544
    s_mov_b64 exec, s[66:67]
    v_lshrrev_b32 v101, 14, v22
    ds_add_rtn_u32 v23, v101, v62 offset:12544
    s_mov_b64 exec, s[68:69]
    v_lshrrev_b32 v102, 14, v26
    ds_add_rtn_u32 v27, v102, v62 offset:12544
    s_mov_b64 exec, s[70:71]
    v_lshrrev_b32 v103, 14, v30
    ds_add_rtn_u32 v31, v103, v62 offset:12544
    s_cmp_lg_u32 s1, 0
    s_cbranch_scc1 L2_x2
L2_x2_r:
    s_mov_b64 exec, -1
    s_cmp_eq_u32 s86, 0
    s_cbranch_scc1 L2_k13
    s_mov_b32 exec_lo, 0
    s_mov_b32 exec_hi, 0x80000000
    ds_max_u32 v63, v115 offset:14596
    s_mov_b64 exec, -1
L2_k13:
    s_waitcnt lgkmcnt(0)
    s_barrier
    ds_read_b32 v48, v161 offset:12544
    ds_read_b32 v49, v161 offset:13568
    ds_read_b64 v[60:61], v63 offset:14592
    s_waitcnt lgkmcnt(1)
    v_add_u32 v50, v48, v49
    v_and_b32 v52, -8, v48
    v_add_u32 v51, 3, v50
    v_mov_b32 v56, v52
    v_and_b32 v51, -4, v51
    v_sub_u32 v54, v51, v52
    v_and_b32 v53, -8, v54
    v_and_b32 v54, 4, v54
    v_mov_b32 v57, v53
    v_mov_b32 v58, v54
    v_add_u32_dpp v56, v56, v56 row_shr:1 row_mask:0xf bank_mask:0xf bound_ctrl:0
    v_add_u32_dpp v57, v57, v57 row_shr:1 row_mask:0xf bank_mask:0xf bound_ctrl:0
    v_add_u32_dpp v58, v58, v58 row_shr:1 row_mask:0xf bank_mask:0xf bound_ctrl:0
    v_add_u32_dpp v56, v56, v56 row_shr:2 row_mask:0xf bank_mask:0xf bound_ctrl:0
    v_add_u32_dpp v57, v57, v57 row_shr:2 row_mask:0xf bank_mask:0xf bound_ctrl:0
    v_add_u32_dpp v58, v58, v58 row_shr:2 row_mask:0xf bank_mask:0xf bound_ctrl:0
    v_add_u32_dpp v56, v56, v56 row_shr:4 row_mask:0xf bank_mask:0xf bound_ctrl:0
    v_add_u32_dpp v57, v57, v57 row_shr:4 row_mask:0xf bank_mask:0xf bound_ctrl:0
    v_add_u32_dpp v58, v58, v58 row_shr:4 row_mask:0xf bank_mask:0xf bound_ctrl:0
    v_add_u32_dpp v56, v56, v56 row_shr:8 row_mask:0xf bank_mask:0xf bound_ctrl:0
    v_add_u32_dpp v57, v57, v57 row_shr:8 row_mask:0xf bank_mask:0xf bound_ctrl:0
    v_add_u32_dpp v58, v58, v58 row_shr:8 row_mask:0xf bank_mask:0xf bound_ctrl:0
    v_add_u32_dpp v56, v56, v56 row_bcast:15 row_mask:0xa bank_mask:0xf
    v_add_u32_dpp v57, v57, v57 row_bcast:15 row_mask:0xa bank_mask:0xf
    v_add_u32_dpp v58, v58, v58 row_bcast:15 row_mask:0xa bank_mask:0xf
    v_add_u32_dpp v56, v56, v56 row_bcast:31 row_mask:0xc bank_mask:0xf
    v_add_u32_dpp v57, v57, v57 row_bcast:31 row_mask:0xc bank_mask:0xf
    v_add_u32_dpp v58, v58, v58 row_bcast:31 row_mask:0xc bank_mask:0xf
    v_readlane_b32 s94, v56, 63
    v_readlane_b32 s95, v57, 63
    v_readlane_b32 s96, v58, 63
    v_readlane_b32 s97, v56, 24
    v_readlane_b32 s98, v57, 24
    v_readlane_b32 s99, v58, 24
    v_readlane_b32 s28, v56, 31
    v_sub_u32 v56, v56, v52
    v_sub_u32 v57, v57, v53
    v_sub_u32 v58, v58, v54
    s_cmp_eq_u32 s86, 0
    s_cbranch_scc1 L2_s1
    s_waitcnt lgkmcnt(0)
    v_readfirstlane_b32 s88, v61
    v_readfirstlane_b32 s89, v60
    s_mov_b32 s86, 0
L2_s1:
    s_sub_u32 s94, s94, s97
    s_sub_u32 s95, s95, s98
    s_sub_u32 s96, s96, s99
    s_add_u32 s29, s97, s98
    s_add_u32 s30, s29, s99
    s_add_u32 s30, s30, 7
    s_and_b32 s30, s30, -8
    s_sub_u32 s31, s30, s97
    s_add_u32 s28, s28, s31
    s_add_u32 s40, s30, s94
    s_add_u32 s41, s40, s95
    s_add_u32 s42, s41, s96
    s_add_u32 s90, s42, 95
    s_lshr_b32 s90, s90, 6
    s_add_u32 s43, s30, 31
    s_lshr_b32 s43, s43, 5
    s_max_u32 s90, s90, s43
    s_add_u32 s43, s28, 31
    s_lshr_b32 s43, s43, 5
    s_min_u32 s90, s90, s43
    s_lshl_b32 s43, s90, 5
    s_max_u32 s43, s43, s28
    s_sub_u32 s43, s43, s28
    s_add_u32 s40, s40, s43
    s_add_u32 s41, s41, s43
    s_add_u32 s42, s42, s43
    s_sub_u32 s40, s40, s98
    s_sub_u32 s52, s41, s99
    s_mov_b32 exec_lo, 33554431
    s_mov_b32 exec_hi, 0
    v_add_u32 v57, s97, v57
    v_add_u32 v58, s29, v58
    s_mov_b32 exec_lo, 4261412864
    s_mov_b32 exec_hi, -1
    v_add_u32 v56, s31, v56
    v_add_u32 v57, s40, v57
    v_add_u32 v58, s52, v58
    s_mov_b32 exec_lo, 0
    v_add_u32 v56, s43, v56
    s_mov_b64 exec, -1
    v_add_u32 v53, v52, v53
    v_sub_u32 v57, v57, v52
    v_sub_u32 v58, v58, v53
    v_lshl_or_b32 v108, v53, 16, v52
    v_mov_b32 v109, v56
    v_mov_b32 v110, v57
    v_mov_b32 v111, v58
    v_max_u32 v55, v53, v48
    v_sub_u32 v55, v55, v48
    v_lshlrev_b32 v112, 16, v55
    v_add_u32 v114, v57, v48
    v_add_u32 v115, v58, v48
    ds_write_b128 v161, v[108:111] offset:10496
    ds_write_b128 v161, v[112:115] offset:11520
    s_add_u32 s96, s42, 31
    s_lshr_b32 s96, s96, 5
    s_cmp_lg_u32 s83, 0
    s_cbranch_scc1 L2_s2
    s_cmp_gt_u32 s96, 60
    s_cselect_b32 s97, 1, 0
    s_cmp_gt_u32 s88, 24
    s_cselect_b32 s97, 1, s97
    s_cmp_lg_u32 s97, 0
    s_cbranch_scc1 L2_ovf
L2_s2:
    s_waitcnt lgkmcnt(0)
    s_mov_b64 exec, s[56:57]
    ds_read_b128 v[104:107], v96 offset:10496
    s_mov_b64 exec, s[58:59]
    ds_read_b128 v[108:111], v97 offset:10496
    s_mov_b64 exec, s[60:61]
    ds_read_b128 v[112:115], v98 offset:10496
    s_mov_b64 exec, s[62:63]
    ds_read_b128 v[116:119], v99 offset:10496
    s_mov_b64 exec, -1
    s_lshr_b32 s29, s29, 6
    s_lshl_b32 s29, s29, 1
    s_lshr_b32 s41, s41, 5
    s_max_u32 s41, s41, s90
    s_sub_u32 s41, s41, s90
    s_and_b32 s41, s41, -2
    s_cmp_eq_u32 s89, 0
    s_cselect_b32 s29, s29, 0
    s_cselect_b32 s41, s41, 0
    s_add_u32 s30, s29, 3
    s_lshr_b32 s30, s30, 2
    s_sub_u32 s31, s90, s29
    s_add_u32 s31, s31, 1
    s_lshr_b32 s31, s31, 1
    s_add_u32 s31, s31, s30
    s_add_u32 s40, s41, 3
    s_lshr_b32 s40, s40, 2
    s_add_u32 s40, s40, s31
    s_min_u32 s98, s90, s96
    s_sub_u32 s99, s96, s98
    s_cmp_eq_u32 s27, 0
    s_cselect_b32 s84, s98, s99
    s_cselect_b32 s85, 0, s90
    s_cselect_b32 s87, s29, s41
    s_cselect_b32 s53, 0, s31
    s_add_u32 s41, s41, s90
    s_lshl_b32 s30, s30, 1
    s_sub_u32 s30, s30, s29
    s_lshl_b32 s31, s31, 2
    s_sub_u32 s31, s31, s90
    s_lshl_b32 s40, s40, 1
    s_sub_u32 s40, s40, s41
    s_waitcnt lgkmcnt(0)
    v_cmp_lt_u32_sdwa s[94:95], v3, v104 src0_sel:DWORD src1_sel:WORD_1
    v_cmp_lt_u32_sdwa s[96:97], v3, v104 src0_sel:DWORD src1_sel:WORD_0
    v_cmp_lt_u32_sdwa s[12:13], v7, v108 src0_sel:DWORD src1_sel:WORD_1
    v_cmp_lt_u32_sdwa s[14:15], v7, v108 src0_sel:DWORD src1_sel:WORD_0
    v_cndmask_b32 v107, v107, v106, s[94:95]
    v_cndmask_b32 v107, v107, v105, s[96:97]
    v_and_b32 v2, 16383, v2
    v_add_lshl_u32 v107, v107, v3, 2
    v_lshlrev_b32 v104, 1, v107
    v_cmp_lt_u32_sdwa s[16:17], v11, v112 src0_sel:DWORD src1_sel:WORD_1
    v_cmp_lt_u32_sdwa s[18:19], v11, v112 src0_sel:DWORD src1_sel:WORD_0
    v_cndmask_b32 v111, v111, v110, s[12:13]
    v_cndmask_b32 v111, v111, v109, s[14:15]
    v_and_b32 v6, 16383, v6
    v_add_lshl_u32 v111, v111, v7, 2
    v_lshlrev_b32 v108, 1, v111
    v_cmp_lt_u32_sdwa s[94:95], v15, v116 src0_sel:DWORD src1_sel:WORD_1
    v_cmp_lt_u32_sdwa s[96:97], v15, v116 src0_sel:DWORD src1_sel:WORD_0
    v_cndmask_b32 v115, v115, v114, s[16:17]
    v_cndmask_b32 v115, v115, v113, s[18:19]
    v_and_b32 v10, 16383, v10
    v_add_lshl_u32 v115, v115, v11, 2
    v_lshlrev_b32 v112, 1, v115
    v_cndmask_b32 v119, v119, v118, s[94:95]
    v_cndmask_b32 v119, v119, v117, s[96:97]
    v_and_b32 v14, 16383, v14
    v_add_lshl_u32 v119, v119, v15, 2
    v_lshlrev_b32 v116, 1, v119
    s_mov_b64 exec, s[56:57]
    ds_write_b32 v107, v2 offset:256
    ds_write_b64 v104, v[0:1] offset:15104
    s_mov_b64 exec, s[58:59]
    ds_write_b32 v111, v6 offset:256
    ds_write_b64 v108, v[4:5] offset:15104
    s_mov_b64 exec, s[60:61]
    ds_write_b32 v115, v10 offset:256
    ds_write_b64 v112, v[8:9] offset:15104
    s_mov_b64 exec, s[62:63]
    ds_write_b32 v119, v14 offset:256
    ds_write_b64 v116, v[12:13] offset:15104
    s_mov_b64 exec, s[64:65]
    ds_read_b128 v[104:107], v100 offset:10496
    s_mov_b64 exec, s[66:67]
    ds_read_b128 v[108:111], v101 offset:10496
    s_mov_b64 exec, s[68:69]
    ds_read_b128 v[112:115], v102 offset:10496
    s_mov_b64 exec, s[70:71]
    ds_read_b128 v[116:119], v103 offset:10496
    s_mov_b64 exec, -1
    v_cmp_eq_u32 vcc, 0, v54
    s_cmp_ge_u32 s3, 3
    s_cbranch_scc1 L2_pad
    v_add_u32 v55, s3, v50
    v_cndmask_b32 v59, v58, v57, vcc
    v_cmp_lt_u32 vcc, v55, v51
    s_lshr_b32 s96, s89, 1
    s_add_u32 s96, s96, 12500
    s_and_b64 exec, exec, vcc
    v_mov_b32 v60, s96
    v_add_lshl_u32 v55, v55, v59, 2
    ds_write_b32 v55, v60 offset:256
    s_mov_b64 exec, -1
L2_pad:
    v_lshrrev_b32 v51, 2, v51
    v_lshrrev_b32 v52, 2, v52
    v_lshrrev_b32 v53, 2, v53
    v_lshrrev_b32 v56, 2, v56
    v_lshrrev_b32 v57, 2, v57
    v_lshrrev_b32 v58, 2, v58
    v_mul_u32_u24 v48, 576, v125
    v_add_u32 v48, 62208, v48
    v_mov_b32 v49, 0x3f80
    v_subrev_u32 v50, 272, v161
    v_mov_b32 v61, s30
    v_mov_b32 v62, s40
    s_mov_b32 s97, s3
L2_q:
    v_cmp_lt_u32 s[94:95], s97, v53
    v_cmp_lt_u32 s[98:99], s97, v52
    v_cmp_lt_u32 vcc, s97, v51
    v_cndmask_b32 v54, v58, v57, s[94:95]
    s_and_b64 exec, exec, vcc
    s_cbranch_execz L2_qd
    v_cndmask_b32 v54, v54, v56, s[98:99]
    v_add_u32 v54, s97, v54
    v_lshrrev_b32 v55, 3, v54
    v_lshlrev_b32 v59, 2, v54
    ds_write_b32 v59, v48 offset:8448
    v_cmp_le_u32 vcc, s90, v55
    v_cmp_gt_u32 s[94:95], s29, v55
    v_cmp_gt_u32 s[98:99], s41, v55
    v_and_b32 v60, 4, v54
    v_cndmask_b32 v59, v161, v50, vcc
    v_lshl_add_u32 v59, v60, 7, v59
    v_and_b32 v60, 2, v54
    v_add_u32 v59, v59, v60
    s_and_b64 s[98:99], s[98:99], vcc
    s_or_b64 s[94:95], s[94:95], s[98:99]
    v_cndmask_b32 v60, v61, v62, vcc
    v_add_u32 v60, v60, v55
    v_and_b32 v54, 1, v54
    v_lshl_or_b32 v54, v60, 1, v54
    v_mov_b32 v60, s31
    v_cndmask_b32 v60, 0, v60, vcc
    v_add_u32 v60, v60, v55
    v_cndmask_b32 v54, v54, v60, s[94:95]
    v_and_b32 v60, -4, v54
    v_lshl_add_u32 v59, v60, 8, v59
    v_and_b32 v60, 3, v54
    v_lshl_add_u32 v59, v60, 2, v59
    ds_write_b16 v59, v49 offset:30464
    s_add_u32 s97, s97, 8
    s_branch L2_q
L2_qd:
    s_mov_b64 exec, -1
    s_waitcnt lgkmcnt(0)
    v_cmp_lt_u32_sdwa s[12:13], v19, v104 src0_sel:DWORD src1_sel:WORD_1
    v_cmp_lt_u32_sdwa s[14:15], v19, v104 src0_sel:DWORD src1_sel:WORD_0
    v_cmp_lt_u32_sdwa s[16:17], v23, v108 src0_sel:DWORD src1_sel:WORD_1
    v_cmp_lt_u32_sdwa s[18:19], v23, v108 src0_sel:DWORD src1_sel:WORD_0
    v_cndmask_b32 v107, v107, v106, s[12:13]
    v_cndmask_b32 v107, v107, v105, s[14:15]
    v_and_b32 v18, 16383, v18
    v_add_lshl_u32 v107, v107, v19, 2
    v_lshlrev_b32 v104, 1, v107
    v_cmp_lt_u32_sdwa s[94:95], v27, v112 src0_sel:DWORD src1_sel:WORD_1
    v_cmp_lt_u32_sdwa s[96:97], v27, v112 src0_sel:DWORD src1_sel:WORD_0
    v_cndmask_b32 v111, v111, v110, s[16:17]
    v_cndmask_b32 v111, v111, v109, s[18:19]
    v_and_b32 v22, 16383, v22
    v_add_lshl_u32 v111, v111, v23, 2
    v_lshlrev_b32 v108, 1, v111
    v_cmp_lt_u32_sdwa s[12:13], v31, v116 src0_sel:DWORD src1_sel:WORD_1
    v_cmp_lt_u32_sdwa s[14:15], v31, v116 src0_sel:DWORD src1_sel:WORD_0
    v_cndmask_b32 v115, v115, v114, s[94:95]
    v_cndmask_b32 v115, v115, v113, s[96:97]
    v_and_b32 v26, 16383, v26
    v_add_lshl_u32 v115, v115, v27, 2
    v_lshlrev_b32 v112, 1, v115
    v_cndmask_b32 v119, v119, v118, s[12:13]
    v_cndmask_b32 v119, v119, v117, s[14:15]
    v_and_b32 v30, 16383, v30
    v_add_lshl_u32 v119, v119, v31, 2
    v_lshlrev_b32 v116, 1, v119
    s_mov_b64 exec, s[64:65]
    ds_write_b32 v107, v18 offset:256
    ds_write_b64 v104, v[16:17] offset:15104
    s_mov_b64 exec, s[66:67]
    ds_write_b32 v111, v22 offset:256
    ds_write_b64 v108, v[20:21] offset:15104
    s_mov_b64 exec, s[68:69]
    ds_write_b32 v115, v26 offset:256
    ds_write_b64 v112, v[24:25] offset:15104
    s_mov_b64 exec, s[70:71]
    ds_write_b32 v119, v30 offset:256
    ds_write_b64 v116, v[28:29] offset:15104
    s_cmp_lg_u32 s1, 0
    s_cbranch_scc1 L2_x4
L2_x4_r:
    s_mov_b64 exec, -1
    s_lshl_b32 s96, s85, 7
    s_add_u32 s96, s96, 0
    v_lshrrev_b32 v54, 3, v125
    v_lshl_add_u32 v163, v54, 2, s96
    s_lshl_b32 s96, s85, 8
    s_add_u32 s96, s96, 14592
    v_add_u32 v164, s96, v126
    s_lshl_b32 s96, s85, 5
    s_add_u32 s96, s96, 8384
    v_add_u32 v165, s96, v127
    s_lshl_b32 s96, s53, 10
    s_add_u32 s96, s96, 29440
    v_add_u32 v166, s96, v161
    v_mov_b32 v56, 0
    v_mov_b32 v57, 0
    v_mov_b32 v58, 0
    v_mov_b32 v59, 0
    v_mov_b32 v60, 0
    v_mov_b32 v61, 0
    v_mov_b32 v62, 0
    v_mov_b32 v63, 0
    v_mov_b32 v144, 0
    v_mov_b32 v33, v149
    v_mov_b32 v145, 0
    v_mov_b32 v35, v151
    v_mov_b32 v146, 0
    v_mov_b32 v37, v153
    v_mov_b32 v147, 0
    v_mov_b32 v39, v155
    s_mov_b32 s38, 12502
L2_b2:
    v_mov_b32 v53, 0
    s_waitcnt vmcnt(0) lgkmcnt(0)
    s_barrier
    ds_read_b64 v[54:55], v53 offset:14600
    ds_read_b32 v148, v163 offset:256
    ds_read_b32 v150, v163 offset:288
    ds_read_b32 v152, v163 offset:320
    ds_read_b32 v154, v163 offset:352
    ds_read_b32 v32, v163 offset:384
    ds_read_b32 v34, v163 offset:416
    ds_read_b32 v36, v163 offset:448
    ds_read_b32 v38, v163 offset:480
    s_waitcnt lgkmcnt(4)
    s_add_u32 m0, s91, 0
    s_nop 0
    buffer_load_dwordx4 v[148:149], s[36:39], 0 idxen offen lds
    s_add_u32 m0, m0, 1024
    s_nop 0
    buffer_load_dwordx4 v[150:151], s[36:39], 0 idxen offen lds
    s_add_u32 m0, m0, 1024
    s_nop 0
    buffer_load_dwordx4 v[152:153], s[36:39], 0 idxen offen lds
    s_add_u32 m0, m0, 1024
    s_nop 0
    buffer_load_dwordx4 v[154:155], s[36:39], 0 idxen offen lds
    ds_read_b32 v148, v163 offset:512
    ds_read_b32 v150, v163 offset:544
    ds_read_b32 v152, v163 offset:576
    ds_read_b32 v154, v163 offset:608
    s_add_u32 m0, s91, 4096
    s_waitcnt lgkmcnt(4)
    buffer_load_dwordx4 v[32:33], s[36:39], 0 idxen offen lds
    s_add_u32 m0, m0, 1024
    s_nop 0
    buffer_load_dwordx4 v[34:35], s[36:39], 0 idxen offen lds
    s_add_u32 m0, m0, 1024
    s_nop 0
    buffer_load_dwordx4 v[36:37], s[36:39], 0 idxen offen lds
    s_add_u32 m0, m0, 1024
    s_nop 0
    buffer_load_dwordx4 v[38:39], s[36:39], 0 idxen offen lds
    ds_read_b32 v156, v165 offset:64
    ds_read_b32 v157, v165 offset:96
    ds_read2st64_b32 v[130:131], v164 offset0:2 offset1:2
    v_readfirstlane_b32 s96, v54
    v_readfirstlane_b32 s97, v55
    s_cmp_eq_u32 s89, 2
    s_cselect_b32 s96, 0, s96
    s_or_b32 s98, s96, s97
    s_cbranch_scc1 L2_again
    s_cmp_eq_u32 s84, 0
    s_cbranch_scc1 L2_done
    s_waitcnt lgkmcnt(0)
    v_add_u32 v156, v156, v158
    v_add_u32 v157, v157, v158
    s_waitcnt vmcnt(4)
    ds_read_b64_tr_b16 v[96:97], v159 offset:0
    ds_read_b64_tr_b16 v[98:99], v159 offset:512
    ds_read_b64_tr_b16 v[100:101], v159 offset:1024
    ds_read_b64_tr_b16 v[102:103], v159 offset:1536
    ds_read_b64_tr_b16 v[104:105], v160 offset:0
    ds_read_b64_tr_b16 v[106:107], v160 offset:512
    ds_read_b64_tr_b16 v[108:109], v160 offset:1024
    ds_read_b64_tr_b16 v[110:111], v160 offset:1536
    ds_read_b64_tr_b16 v[136:137], v156
    s_waitcnt lgkmcnt(0)
    v_mfma_f32_32x32x16_bf16 v[0:15], v[128:131], v[136:139], 0
    v_smfmac_f32_32x32x32_bf16 v[0:15], v[120:123], v[96:103], v124
    s_add_u32 m0, s91, 0
    s_nop 0
    buffer_load_dwordx4 v[148:149], s[36:39], 0 idxen offen lds
    s_add_u32 m0, m0, 1024
    s_nop 0
    buffer_load_dwordx4 v[150:151], s[36:39], 0 idxen offen lds
    s_add_u32 m0, m0, 1024
    s_nop 0
    buffer_load_dwordx4 v[152:153], s[36:39], 0 idxen offen lds
    s_add_u32 m0, m0, 1024
    s_nop 0
    buffer_load_dwordx4 v[154:155], s[36:39], 0 idxen offen lds
    ds_read_b32 v148, v163 offset:640
    ds_read_b32 v150, v163 offset:672
    ds_read_b32 v152, v163 offset:704
    ds_read_b32 v154, v163 offset:736
    s_waitcnt vmcnt(4)
    ds_read_b64_tr_b16 v[96:97], v159 offset:4096
    ds_read_b64_tr_b16 v[98:99], v159 offset:4608
    ds_read_b64_tr_b16 v[100:101], v159 offset:5120
    ds_read_b64_tr_b16 v[102:103], v159 offset:5632
    ds_read_b64_tr_b16 v[112:113], v160 offset:4096
    ds_read_b64_tr_b16 v[114:115], v160 offset:4608
    ds_read_b64_tr_b16 v[116:117], v160 offset:5120
    ds_read_b64_tr_b16 v[118:119], v160 offset:5632
    ds_read_b64_tr_b16 v[140:141], v156 offset:64
    ds_read_b64_tr_b16 v[136:137], v157
    ds_read2st64_b32 v[134:135], v164 offset0:3 offset1:3
    s_cmp_gt_u32 s84, 3
    s_cselect_b32 s38, 12502, 0
    s_waitcnt lgkmcnt(3)
    s_add_u32 m0, s91, 4096
    s_nop 0
    buffer_load_dwordx4 v[148:149], s[36:39], 0 idxen offen lds
    s_add_u32 m0, m0, 1024
    s_nop 0
    buffer_load_dwordx4 v[150:151], s[36:39], 0 idxen offen lds
    s_add_u32 m0, m0, 1024
    s_nop 0
    buffer_load_dwordx4 v[152:153], s[36:39], 0 idxen offen lds
    s_add_u32 m0, m0, 1024
    s_nop 0
    buffer_load_dwordx4 v[154:155], s[36:39], 0 idxen offen lds
    ds_read_b32 v148, v163 offset:768
    ds_read_b32 v150, v163 offset:800
    ds_read_b32 v152, v163 offset:832
    ds_read_b32 v154, v163 offset:864
    ds_read_b32 v156, v165 offset:128
    s_waitcnt lgkmcnt(5)
    s_cmp_eq_u32 s89, 2
    s_cbranch_scc1 L2_loopS
    s_cmp_eq_u32 s87, 0
    s_cbranch_scc1 L2_loopF
L2_loopO:
    v_mfma_f32_32x32x16_bf16 v[16:31], v[128:131], v[140:143], 0
    v_exp_f32 v32, v0
    v_exp_f32 v33, v1
    v_exp_f32 v34, v2
    v_smfmac_f32_32x32x32_bf16 v[16:31], v[120:123], v[104:111], v124
    v_exp_f32 v35, v3
    v_exp_f32 v36, v4
    v_exp_f32 v37, v5
    v_mfma_f32_32x32x16_bf16 v[80:95], v[60:63], v[144:147], v[80:95]
    v_exp_f32 v38, v6
    v_exp_f32 v39, v7
    v_exp_f32 v40, v8
    v_exp_f32 v41, v9
    v_pk_add_f32 v[48:49], v[32:33], 1.0 op_sel_hi:[1,0]
    v_pk_fma_f32 v[50:51], v[0:1], v[34:35], v[0:1]
    v_pk_fma_f32 v[50:51], v[2:3], v[48:49], v[50:51]
    v_exp_f32 v42, v10
    v_pk_fma_f32 v[48:49], v[48:49], v[34:35], v[48:49]
    v_pk_fma_f32 v[50:51], v[50:51], v[36:37], v[50:51]
    v_pk_fma_f32 v[50:51], v[4:5], v[48:49], v[50:51]
    v_exp_f32 v43, v11
    v_pk_fma_f32 v[48:49], v[48:49], v[36:37], v[48:49]
    v_pk_fma_f32 v[50:51], v[50:51], v[38:39], v[50:51]
    v_pk_fma_f32 v[50:51], v[6:7], v[48:49], v[50:51]
    v_exp_f32 v44, v12
    v_pk_fma_f32 v[48:49], v[48:49], v[38:39], v[48:49]
    v_pk_fma_f32 v[50:51], v[50:51], v[40:41], v[50:51]
    v_pk_fma_f32 v[50:51], v[8:9], v[48:49], v[50:51]
    v_exp_f32 v45, v13
    v_pk_fma_f32 v[48:49], v[48:49], v[40:41], v[48:49]
    v_pk_fma_f32 v[50:51], v[50:51], v[42:43], v[50:51]
    v_pk_fma_f32 v[50:51], v[10:11], v[48:49], v[50:51]
    s_setprio 1
    v_exp_f32 v46, v14
    v_pk_fma_f32 v[48:49], v[48:49], v[42:43], v[48:49]
    v_pk_fma_f32 v[50:51], v[50:51], v[44:45], v[50:51]
    v_pk_fma_f32 v[50:51], v[12:13], v[48:49], v[50:51]
    v_exp_f32 v47, v15
    v_pk_fma_f32 v[48:49], v[48:49], v[44:45], v[48:49]
    v_pk_fma_f32 v[52:53], v[48:49], v[46:47], v[48:49]
    v_rcp_f32 v52, v52
    v_rcp_f32 v53, v53
    v_pk_fma_f32 v[50:51], v[50:51], v[46:47], v[50:51]
    v_pk_fma_f32 v[50:51], v[14:15], v[48:49], v[50:51]
    v_pk_mul_f32 v[50:51], v[50:51], v[52:53]
    v_cvt_pk_bf16_f32 v56, v50, v51
    s_waitcnt lgkmcnt(0)
    v_add_u32 v156, v156, v158
    v_add_u32 v166, 1024, v166
    v_mfma_f32_32x32x16_bf16 v[0:15], v[132:135], v[136:139], 0
    v_exp_f32 v32, v16
    v_exp_f32 v33, v17
    v_exp_f32 v34, v18
    v_smfmac_f32_32x32x32_bf16 v[0:15], v[120:123], v[96:103], v124
    v_exp_f32 v35, v19
    v_exp_f32 v36, v20
    v_exp_f32 v37, v21
    v_exp_f32 v38, v22
    v_exp_f32 v39, v23
    v_exp_f32 v40, v24
    v_exp_f32 v41, v25
    v_pk_add_f32 v[48:49], v[32:33], 1.0 op_sel_hi:[1,0]
    v_pk_fma_f32 v[50:51], v[16:17], v[34:35], v[16:17]
    v_pk_fma_f32 v[50:51], v[18:19], v[48:49], v[50:51]
    v_exp_f32 v42, v26
    v_pk_fma_f32 v[48:49], v[48:49], v[34:35], v[48:49]
    v_pk_fma_f32 v[50:51], v[50:51], v[36:37], v[50:51]
    v_pk_fma_f32 v[50:51], v[20:21], v[48:49], v[50:51]
    v_exp_f32 v43, v27
    v_pk_fma_f32 v[48:49], v[48:49], v[36:37], v[48:49]
    v_pk_fma_f32 v[50:51], v[50:51], v[38:39], v[50:51]
    v_pk_fma_f32 v[50:51], v[22:23], v[48:49], v[50:51]
    v_exp_f32 v44, v28
    v_pk_fma_f32 v[48:49], v[48:49], v[38:39], v[48:49]
    v_pk_fma_f32 v[50:51], v[50:51], v[40:41], v[50:51]
    v_pk_fma_f32 v[50:51], v[24:25], v[48:49], v[50:51]
    v_exp_f32 v45, v29
    v_pk_fma_f32 v[48:49], v[48:49], v[40:41], v[48:49]
    v_pk_fma_f32 v[50:51], v[50:51], v[42:43], v[50:51]
    v_pk_fma_f32 v[50:51], v[26:27], v[48:49], v[50:51]
    v_exp_f32 v46, v30
    v_pk_fma_f32 v[48:49], v[48:49], v[42:43], v[48:49]
    v_pk_fma_f32 v[50:51], v[50:51], v[44:45], v[50:51]
    v_pk_fma_f32 v[50:51], v[28:29], v[48:49], v[50:51]
    v_exp_f32 v47, v31
    v_pk_fma_f32 v[48:49], v[48:49], v[44:45], v[48:49]
    v_pk_fma_f32 v[52:53], v[48:49], v[46:47], v[48:49]
    v_rcp_f32 v52, v52
    v_rcp_f32 v53, v53
    v_pk_fma_f32 v[50:51], v[50:51], v[46:47], v[50:51]
    v_pk_fma_f32 v[50:51], v[30:31], v[48:49], v[50:51]
    v_pk_mul_f32 v[50:51], v[50:51], v[52:53]
    v_cvt_pk_bf16_f32 v60, v50, v51
    s_setprio 0
    s_sub_u32 s84, s84, 1
    s_waitcnt vmcnt(4)
    ds_read_b64_tr_b16 v[96:97], v159 offset:0
    ds_read_b64_tr_b16 v[98:99], v159 offset:512
    ds_read_b64_tr_b16 v[100:101], v159 offset:1024
    ds_read_b64_tr_b16 v[102:103], v159 offset:1536
    ds_read_b64_tr_b16 v[104:105], v160 offset:0
    ds_read_b64_tr_b16 v[106:107], v160 offset:512
    ds_read_b64_tr_b16 v[108:109], v160 offset:1024
    ds_read_b64_tr_b16 v[110:111], v160 offset:1536
    ds_read_b64_tr_b16 v[140:141], v157 offset:64
    ds_read_b64_tr_b16 v[136:137], v156
    ds_read2st64_b32 v[130:131], v164 offset0:4 offset1:4
    ds_read_b128 v[144:147], v166
    s_cmp_gt_u32 s84, 3
    s_cselect_b32 s38, 12502, 0
    s_waitcnt lgkmcnt(4)
    s_add_u32 m0, s91, 0
    s_nop 0
    buffer_load_dwordx4 v[148:149], s[36:39], 0 idxen offen lds
    s_add_u32 m0, m0, 1024
    s_nop 0
    buffer_load_dwordx4 v[150:151], s[36:39], 0 idxen offen lds
    s_add_u32 m0, m0, 1024
    s_nop 0
    buffer_load_dwordx4 v[152:153], s[36:39], 0 idxen offen lds
    s_add_u32 m0, m0, 1024
    s_nop 0
    buffer_load_dwordx4 v[154:155], s[36:39], 0 idxen offen lds
    ds_read_b32 v148, v163 offset:896
    ds_read_b32 v150, v163 offset:928
    ds_read_b32 v152, v163 offset:960
    ds_read_b32 v154, v163 offset:992
    ds_read_b32 v157, v165 offset:160
    s_waitcnt lgkmcnt(5)
    v_mfma_f32_32x32x16_bf16 v[16:31], v[132:135], v[140:143], 0
    v_exp_f32 v32, v0
    v_exp_f32 v33, v1
    v_exp_f32 v34, v2
    v_smfmac_f32_32x32x32_bf16 v[16:31], v[120:123], v[112:119], v124
    v_exp_f32 v35, v3
    v_exp_f32 v36, v4
    v_exp_f32 v37, v5
    v_exp_f32 v38, v6
    v_exp_f32 v39, v7
    v_exp_f32 v40, v8
    v_exp_f32 v41, v9
    v_pk_add_f32 v[48:49], v[32:33], 1.0 op_sel_hi:[1,0]
    v_pk_fma_f32 v[50:51], v[0:1], v[34:35], v[0:1]
    v_pk_fma_f32 v[50:51], v[2:3], v[48:49], v[50:51]
    v_exp_f32 v42, v10
    v_pk_fma_f32 v[48:49], v[48:49], v[34:35], v[48:49]
    v_pk_fma_f32 v[50:51], v[50:51], v[36:37], v[50:51]
    v_pk_fma_f32 v[50:51], v[4:5], v[48:49], v[50:51]
    v_exp_f32 v43, v11
    v_pk_fma_f32 v[48:49], v[48:49], v[36:37], v[48:49]
    v_pk_fma_f32 v[50:51], v[50:51], v[38:39], v[50:51]
    v_pk_fma_f32 v[50:51], v[6:7], v[48:49], v[50:51]
    v_exp_f32 v44, v12
    v_pk_fma_f32 v[48:49], v[48:49], v[38:39], v[48:49]
    v_pk_fma_f32 v[50:51], v[50:51], v[40:41], v[50:51]
    v_pk_fma_f32 v[50:51], v[8:9], v[48:49], v[50:51]
    v_exp_f32 v45, v13
    v_pk_fma_f32 v[48:49], v[48:49], v[40:41], v[48:49]
    v_pk_fma_f32 v[50:51], v[50:51], v[42:43], v[50:51]
    v_pk_fma_f32 v[50:51], v[10:11], v[48:49], v[50:51]
    v_exp_f32 v46, v14
    s_setprio 1
    v_pk_fma_f32 v[48:49], v[48:49], v[42:43], v[48:49]
    v_pk_fma_f32 v[50:51], v[50:51], v[44:45], v[50:51]
    v_pk_fma_f32 v[50:51], v[12:13], v[48:49], v[50:51]
    v_exp_f32 v47, v15
    v_pk_fma_f32 v[48:49], v[48:49], v[44:45], v[48:49]
    v_pk_fma_f32 v[52:53], v[48:49], v[46:47], v[48:49]
    v_rcp_f32 v52, v52
    v_rcp_f32 v53, v53
    v_pk_fma_f32 v[50:51], v[50:51], v[46:47], v[50:51]
    v_pk_fma_f32 v[50:51], v[14:15], v[48:49], v[50:51]
    v_pk_mul_f32 v[50:51], v[50:51], v[52:53]
    v_cvt_pk_bf16_f32 v57, v50, v51
    s_waitcnt lgkmcnt(0)
    v_add_u32 v157, v157, v158
    v_mfma_f32_32x32x16_bf16 v[0:15], v[128:131], v[136:139], 0
    v_exp_f32 v32, v16
    v_exp_f32 v33, v17
    v_exp_f32 v34, v18
    v_smfmac_f32_32x32x32_bf16 v[0:15], v[120:123], v[96:103], v124
    v_exp_f32 v35, v19
    v_exp_f32 v36, v20
    v_exp_f32 v37, v21
    v_exp_f32 v38, v22
    v_exp_f32 v39, v23
    v_exp_f32 v40, v24
    v_exp_f32 v41, v25
    v_pk_add_f32 v[48:49], v[32:33], 1.0 op_sel_hi:[1,0]
    v_pk_fma_f32 v[50:51], v[16:17], v[34:35], v[16:17]
    v_pk_fma_f32 v[50:51], v[18:19], v[48:49], v[50:51]
    v_exp_f32 v42, v26
    v_pk_fma_f32 v[48:49], v[48:49], v[34:35], v[48:49]
    v_pk_fma_f32 v[50:51], v[50:51], v[36:37], v[50:51]
    v_pk_fma_f32 v[50:51], v[20:21], v[48:49], v[50:51]
    v_exp_f32 v43, v27
    v_pk_fma_f32 v[48:49], v[48:49], v[36:37], v[48:49]
    v_pk_fma_f32 v[50:51], v[50:51], v[38:39], v[50:51]
    v_pk_fma_f32 v[50:51], v[22:23], v[48:49], v[50:51]
    v_exp_f32 v44, v28
    v_pk_fma_f32 v[48:49], v[48:49], v[38:39], v[48:49]
    v_pk_fma_f32 v[50:51], v[50:51], v[40:41], v[50:51]
    v_pk_fma_f32 v[50:51], v[24:25], v[48:49], v[50:51]
    v_exp_f32 v45, v29
    v_pk_fma_f32 v[48:49], v[48:49], v[40:41], v[48:49]
    v_pk_fma_f32 v[50:51], v[50:51], v[42:43], v[50:51]
    v_pk_fma_f32 v[50:51], v[26:27], v[48:49], v[50:51]
    v_exp_f32 v46, v30
    v_pk_fma_f32 v[48:49], v[48:49], v[42:43], v[48:49]
    v_pk_fma_f32 v[50:51], v[50:51], v[44:45], v[50:51]
    v_pk_fma_f32 v[50:51], v[28:29], v[48:49], v[50:51]
    v_exp_f32 v47, v31
    v_pk_fma_f32 v[48:49], v[48:49], v[44:45], v[48:49]
    v_pk_fma_f32 v[52:53], v[48:49], v[46:47], v[48:49]
    v_rcp_f32 v52, v52
    v_rcp_f32 v53, v53
    v_pk_fma_f32 v[50:51], v[50:51], v[46:47], v[50:51]
    v_pk_fma_f32 v[50:51], v[30:31], v[48:49], v[50:51]
    v_pk_mul_f32 v[50:51], v[50:51], v[52:53]
    v_cvt_pk_bf16_f32 v61, v50, v51
    s_setprio 0
    s_sub_u32 s84, s84, 1
    s_cmp_eq_u32 s84, 0
    s_cbranch_scc1 L2_end_odd
    s_waitcnt vmcnt(4)
    ds_read_b64_tr_b16 v[96:97], v159 offset:4096
    ds_read_b64_tr_b16 v[98:99], v159 offset:4608
    ds_read_b64_tr_b16 v[100:101], v159 offset:5120
    ds_read_b64_tr_b16 v[102:103], v159 offset:5632
    ds_read_b64_tr_b16 v[112:113], v160 offset:4096
    ds_read_b64_tr_b16 v[114:115], v160 offset:4608
    ds_read_b64_tr_b16 v[116:117], v160 offset:5120
    ds_read_b64_tr_b16 v[118:119], v160 offset:5632
    ds_read_b64_tr_b16 v[140:141], v156 offset:64
    ds_read_b64_tr_b16 v[136:137], v157
    ds_read2st64_b32 v[134:135], v164 offset0:5 offset1:5
    s_cmp_gt_u32 s84, 3
    s_cselect_b32 s38, 12502, 0
    s_waitcnt lgkmcnt(3)
    s_add_u32 m0, s91, 4096
    s_nop 0
    buffer_load_dwordx4 v[148:149], s[36:39], 0 idxen offen lds
    s_add_u32 m0, m0, 1024
    s_nop 0
    buffer_load_dwordx4 v[150:151], s[36:39], 0 idxen offen lds
    s_add_u32 m0, m0, 1024
    s_nop 0
    buffer_load_dwordx4 v[152:153], s[36:39], 0 idxen offen lds
    s_add_u32 m0, m0, 1024
    s_nop 0
    buffer_load_dwordx4 v[154:155], s[36:39], 0 idxen offen lds
    ds_read_b32 v148, v163 offset:1024
    ds_read_b32 v150, v163 offset:1056
    ds_read_b32 v152, v163 offset:1088
    ds_read_b32 v154, v163 offset:1120
    ds_read_b32 v156, v165 offset:192
    s_waitcnt lgkmcnt(5)
    s_cmp_eq_u32 s87, 2
    s_cbranch_scc1 L2_half
    v_mfma_f32_32x32x16_bf16 v[16:31], v[128:131], v[140:143], 0
    v_exp_f32 v32, v0
    v_exp_f32 v33, v1
    v_exp_f32 v34, v2
    v_smfmac_f32_32x32x32_bf16 v[16:31], v[120:123], v[104:111], v124
    v_exp_f32 v35, v3
    v_exp_f32 v36, v4
    v_exp_f32 v37, v5
    v_exp_f32 v38, v6
    v_exp_f32 v39, v7
    v_exp_f32 v40, v8
    v_exp_f32 v41, v9
    v_pk_add_f32 v[48:49], v[32:33], 1.0 op_sel_hi:[1,0]
    v_pk_fma_f32 v[50:51], v[0:1], v[34:35], v[0:1]
    v_pk_fma_f32 v[50:51], v[2:3], v[48:49], v[50:51]
    v_exp_f32 v42, v10
    v_pk_fma_f32 v[48:49], v[48:49], v[34:35], v[48:49]
    v_pk_fma_f32 v[50:51], v[50:51], v[36:37], v[50:51]
    v_pk_fma_f32 v[50:51], v[4:5], v[48:49], v[50:51]
    v_exp_f32 v43, v11
    v_pk_fma_f32 v[48:49], v[48:49], v[36:37], v[48:49]
    v_pk_fma_f32 v[50:51], v[50:51], v[38:39], v[50:51]
    v_pk_fma_f32 v[50:51], v[6:7], v[48:49], v[50:51]
    v_exp_f32 v44, v12
    v_pk_fma_f32 v[48:49], v[48:49], v[38:39], v[48:49]
    v_pk_fma_f32 v[50:51], v[50:51], v[40:41], v[50:51]
    v_pk_fma_f32 v[50:51], v[8:9], v[48:49], v[50:51]
    v_exp_f32 v45, v13
    v_pk_fma_f32 v[48:49], v[48:49], v[40:41], v[48:49]
    v_pk_fma_f32 v[50:51], v[50:51], v[42:43], v[50:51]
    v_pk_fma_f32 v[50:51], v[10:11], v[48:49], v[50:51]
    v_exp_f32 v46, v14
    s_setprio 1
    v_pk_fma_f32 v[48:49], v[48:49], v[42:43], v[48:49]
    v_pk_fma_f32 v[50:51], v[50:51], v[44:45], v[50:51]
    v_pk_fma_f32 v[50:51], v[12:13], v[48:49], v[50:51]
    v_exp_f32 v47, v15
    v_pk_fma_f32 v[48:49], v[48:49], v[44:45], v[48:49]
    v_pk_fma_f32 v[52:53], v[48:49], v[46:47], v[48:49]
    v_rcp_f32 v52, v52
    v_rcp_f32 v53, v53
    v_pk_fma_f32 v[50:51], v[50:51], v[46:47], v[50:51]
    v_pk_fma_f32 v[50:51], v[14:15], v[48:49], v[50:51]
    v_pk_mul_f32 v[50:51], v[50:51], v[52:53]
    v_cvt_pk_bf16_f32 v58, v50, v51
    s_waitcnt lgkmcnt(0)
    v_add_u32 v156, v156, v158
    v_add_u32 v163, 512, v163
    v_add_u32 v164, 1024, v164
    v_add_u32 v165, 128, v165
    v_mfma_f32_32x32x16_bf16 v[0:15], v[132:135], v[136:139], 0
    v_exp_f32 v32, v16
    v_exp_f32 v33, v17
    v_exp_f32 v34, v18
    v_smfmac_f32_32x32x32_bf16 v[0:15], v[120:123], v[96:103], v124
    v_exp_f32 v35, v19
    v_exp_f32 v36, v20
    v_exp_f32 v37, v21
    v_exp_f32 v38, v22
    v_exp_f32 v39, v23
    v_exp_f32 v40, v24
    v_exp_f32 v41, v25
    v_pk_add_f32 v[48:49], v[32:33], 1.0 op_sel_hi:[1,0]
    v_pk_fma_f32 v[50:51], v[16:17], v[34:35], v[16:17]
    v_pk_fma_f32 v[50:51], v[18:19], v[48:49], v[50:51]
    v_exp_f32 v42, v26
    v_pk_fma_f32 v[48:49], v[48:49], v[34:35], v[48:49]
    v_pk_fma_f32 v[50:51], v[50:51], v[36:37], v[50:51]
    v_pk_fma_f32 v[50:51], v[20:21], v[48:49], v[50:51]
    v_exp_f32 v43, v27
    v_pk_fma_f32 v[48:49], v[48:49], v[36:37], v[48:49]
    v_pk_fma_f32 v[50:51], v[50:51], v[38:39], v[50:51]
    v_pk_fma_f32 v[50:51], v[22:23], v[48:49], v[50:51]
    v_exp_f32 v44, v28
    v_pk_fma_f32 v[48:49], v[48:49], v[38:39], v[48:49]
    v_pk_fma_f32 v[50:51], v[50:51], v[40:41], v[50:51]
    v_pk_fma_f32 v[50:51], v[24:25], v[48:49], v[50:51]
    v_exp_f32 v45, v29
    v_pk_fma_f32 v[48:49], v[48:49], v[40:41], v[48:49]
    v_pk_fma_f32 v[50:51], v[50:51], v[42:43], v[50:51]
    v_pk_fma_f32 v[50:51], v[26:27], v[48:49], v[50:51]
    v_exp_f32 v46, v30
    v_pk_fma_f32 v[48:49], v[48:49], v[42:43], v[48:49]
    v_pk_fma_f32 v[50:51], v[50:51], v[44:45], v[50:51]
    v_pk_fma_f32 v[50:51], v[28:29], v[48:49], v[50:51]
    v_exp_f32 v47, v31
    v_pk_fma_f32 v[48:49], v[48:49], v[44:45], v[48:49]
    v_pk_fma_f32 v[52:53], v[48:49], v[46:47], v[48:49]
    v_rcp_f32 v52, v52
    v_rcp_f32 v53, v53
    v_pk_fma_f32 v[50:51], v[50:51], v[46:47], v[50:51]
    v_pk_fma_f32 v[50:51], v[30:31], v[48:49], v[50:51]
    v_pk_mul_f32 v[50:51], v[50:51], v[52:53]
    v_cvt_pk_bf16_f32 v62, v50, v51
    s_setprio 0
    s_sub_u32 s84, s84, 1
    s_waitcnt vmcnt(4)
    ds_read_b64_tr_b16 v[96:97], v159 offset:0
    ds_read_b64_tr_b16 v[98:99], v159 offset:512
    ds_read_b64_tr_b16 v[100:101], v159 offset:1024
    ds_read_b64_tr_b16 v[102:103], v159 offset:1536
    ds_read_b64_tr_b16 v[104:105], v160 offset:0
    ds_read_b64_tr_b16 v[106:107], v160 offset:512
    ds_read_b64_tr_b16 v[108:109], v160 offset:1024
    ds_read_b64_tr_b16 v[110:111], v160 offset:1536
    ds_read_b64_tr_b16 v[140:141], v157 offset:64
    ds_read_b64_tr_b16 v[136:137], v156
    ds_read2st64_b32 v[130:131], v164 offset0:2 offset1:2
    s_cmp_gt_u32 s84, 3
    s_cselect_b32 s38, 12502, 0
    s_waitcnt lgkmcnt(3)
    s_add_u32 m0, s91, 0
    s_nop 0
    buffer_load_dwordx4 v[148:149], s[36:39], 0 idxen offen lds
    s_add_u32 m0, m0, 1024
    s_nop 0
    buffer_load_dwordx4 v[150:151], s[36:39], 0 idxen offen lds
    s_add_u32 m0, m0, 1024
    s_nop 0
    buffer_load_dwordx4 v[152:153], s[36:39], 0 idxen offen lds
    s_add_u32 m0, m0, 1024
    s_nop 0
    buffer_load_dwordx4 v[154:155], s[36:39], 0 idxen offen lds
    ds_read_b32 v148, v163 offset:640
    ds_read_b32 v150, v163 offset:672
    ds_read_b32 v152, v163 offset:704
    ds_read_b32 v154, v163 offset:736
    ds_read_b32 v157, v165 offset:96
    s_waitcnt lgkmcnt(5)
    v_mfma_f32_32x32x16_bf16 v[16:31], v[132:135], v[140:143], 0
    v_exp_f32 v32, v0
    v_exp_f32 v33, v1
    v_exp_f32 v34, v2
    v_smfmac_f32_32x32x32_bf16 v[16:31], v[120:123], v[112:119], v124
    v_exp_f32 v35, v3
    v_exp_f32 v36, v4
    v_exp_f32 v37, v5
    v_exp_f32 v38, v6
    v_exp_f32 v39, v7
    v_exp_f32 v40, v8
    v_exp_f32 v41, v9
    v_pk_add_f32 v[48:49], v[32:33], 1.0 op_sel_hi:[1,0]
    v_pk_fma_f32 v[50:51], v[0:1], v[34:35], v[0:1]
    v_pk_fma_f32 v[50:51], v[2:3], v[48:49], v[50:51]
    v_exp_f32 v42, v10
    v_pk_fma_f32 v[48:49], v[48:49], v[34:35], v[48:49]
    v_pk_fma_f32 v[50:51], v[50:51], v[36:37], v[50:51]
    v_pk_fma_f32 v[50:51], v[4:5], v[48:49], v[50:51]
    v_exp_f32 v43, v11
    v_pk_fma_f32 v[48:49], v[48:49], v[36:37], v[48:49]
    v_pk_fma_f32 v[50:51], v[50:51], v[38:39], v[50:51]
    v_pk_fma_f32 v[50:51], v[6:7], v[48:49], v[50:51]
    v_exp_f32 v44, v12
    v_pk_fma_f32 v[48:49], v[48:49], v[38:39], v[48:49]
    v_pk_fma_f32 v[50:51], v[50:51], v[40:41], v[50:51]
    v_pk_fma_f32 v[50:51], v[8:9], v[48:49], v[50:51]
    v_exp_f32 v45, v13
    v_pk_fma_f32 v[48:49], v[48:49], v[40:41], v[48:49]
    v_pk_fma_f32 v[50:51], v[50:51], v[42:43], v[50:51]
    v_pk_fma_f32 v[50:51], v[10:11], v[48:49], v[50:51]
    v_exp_f32 v46, v14
    s_setprio 1
    v_pk_fma_f32 v[48:49], v[48:49], v[42:43], v[48:49]
    v_pk_fma_f32 v[50:51], v[50:51], v[44:45], v[50:51]
    v_pk_fma_f32 v[50:51], v[12:13], v[48:49], v[50:51]
    v_exp_f32 v47, v15
    v_pk_fma_f32 v[48:49], v[48:49], v[44:45], v[48:49]
    v_pk_fma_f32 v[52:53], v[48:49], v[46:47], v[48:49]
    v_rcp_f32 v52, v52
    v_rcp_f32 v53, v53
    v_pk_fma_f32 v[50:51], v[50:51], v[46:47], v[50:51]
    v_pk_fma_f32 v[50:51], v[14:15], v[48:49], v[50:51]
    v_pk_mul_f32 v[50:51], v[50:51], v[52:53]
    v_cvt_pk_bf16_f32 v59, v50, v51
    s_waitcnt lgkmcnt(0)
    v_add_u32 v157, v157, v158
    v_mfma_f32_32x32x16_bf16 v[0:15], v[128:131], v[136:139], 0
    v_exp_f32 v32, v16
    v_exp_f32 v33, v17
    v_exp_f32 v34, v18
    v_smfmac_f32_32x32x32_bf16 v[0:15], v[120:123], v[96:103], v124
    v_exp_f32 v35, v19
    v_exp_f32 v36, v20
    v_exp_f32 v37, v21
    v_mfma_f32_32x32x16_bf16 v[64:79], v[56:59], v[144:147], v[64:79]
    v_exp_f32 v38, v22
    v_exp_f32 v39, v23
    v_exp_f32 v40, v24
    v_exp_f32 v41, v25
    v_pk_add_f32 v[48:49], v[32:33], 1.0 op_sel_hi:[1,0]
    v_pk_fma_f32 v[50:51], v[16:17], v[34:35], v[16:17]
    v_pk_fma_f32 v[50:51], v[18:19], v[48:49], v[50:51]
    v_exp_f32 v42, v26
    v_pk_fma_f32 v[48:49], v[48:49], v[34:35], v[48:49]
    v_pk_fma_f32 v[50:51], v[50:51], v[36:37], v[50:51]
    v_pk_fma_f32 v[50:51], v[20:21], v[48:49], v[50:51]
    v_exp_f32 v43, v27
    v_pk_fma_f32 v[48:49], v[48:49], v[36:37], v[48:49]
    v_pk_fma_f32 v[50:51], v[50:51], v[38:39], v[50:51]
    v_pk_fma_f32 v[50:51], v[22:23], v[48:49], v[50:51]
    v_exp_f32 v44, v28
    v_pk_fma_f32 v[48:49], v[48:49], v[38:39], v[48:49]
    v_pk_fma_f32 v[50:51], v[50:51], v[40:41], v[50:51]
    v_pk_fma_f32 v[50:51], v[24:25], v[48:49], v[50:51]
    v_exp_f32 v45, v29
    v_pk_fma_f32 v[48:49], v[48:49], v[40:41], v[48:49]
    v_pk_fma_f32 v[50:51], v[50:51], v[42:43], v[50:51]
    v_pk_fma_f32 v[50:51], v[26:27], v[48:49], v[50:51]
    v_exp_f32 v46, v30
    v_pk_fma_f32 v[48:49], v[48:49], v[42:43], v[48:49]
    v_pk_fma_f32 v[50:51], v[50:51], v[44:45], v[50:51]
    v_pk_fma_f32 v[50:51], v[28:29], v[48:49], v[50:51]
    v_exp_f32 v47, v31
    v_pk_fma_f32 v[48:49], v[48:49], v[44:45], v[48:49]
    v_pk_fma_f32 v[52:53], v[48:49], v[46:47], v[48:49]
    v_rcp_f32 v52, v52
    v_rcp_f32 v53, v53
    v_pk_fma_f32 v[50:51], v[50:51], v[46:47], v[50:51]
    v_pk_fma_f32 v[50:51], v[30:31], v[48:49], v[50:51]
    v_pk_mul_f32 v[50:51], v[50:51], v[52:53]
    v_cvt_pk_bf16_f32 v63, v50, v51
    s_setprio 0
    s_sub_u32 s84, s84, 1
    s_cmp_eq_u32 s84, 0
    s_cbranch_scc1 L2_end_even
    s_waitcnt vmcnt(4)
    ds_read_b64_tr_b16 v[96:97], v159 offset:4096
    ds_read_b64_tr_b16 v[98:99], v159 offset:4608
    ds_read_b64_tr_b16 v[100:101], v159 offset:5120
    ds_read_b64_tr_b16 v[102:103], v159 offset:5632
    ds_read_b64_tr_b16 v[112:113], v160 offset:4096
    ds_read_b64_tr_b16 v[114:115], v160 offset:4608
    ds_read_b64_tr_b16 v[116:117], v160 offset:5120
    ds_read_b64_tr_b16 v[118:119], v160 offset:5632
    ds_read_b64_tr_b16 v[140:141], v156 offset:64
    ds_read_b64_tr_b16 v[136:137], v157
    ds_read2st64_b32 v[134:135], v164 offset0:3 offset1:3
    s_cmp_gt_u32 s84, 3
    s_cselect_b32 s38, 12502, 0
    s_waitcnt lgkmcnt(3)
    s_add_u32 m0, s91, 4096
    s_nop 0
    buffer_load_dwordx4 v[148:149], s[36:39], 0 idxen offen lds
    s_add_u32 m0, m0, 1024
    s_nop 0
    buffer_load_dwordx4 v[150:151], s[36:39], 0 idxen offen lds
    s_add_u32 m0, m0, 1024
    s_nop 0
    buffer_load_dwordx4 v[152:153], s[36:39], 0 idxen offen lds
    s_add_u32 m0, m0, 1024
    s_nop 0
    buffer_load_dwordx4 v[154:155], s[36:39], 0 idxen offen lds
    ds_read_b32 v148, v163 offset:768
    ds_read_b32 v150, v163 offset:800
    ds_read_b32 v152, v163 offset:832
    ds_read_b32 v154, v163 offset:864
    ds_read_b32 v156, v165 offset:128
    s_waitcnt lgkmcnt(5)
    s_sub_u32 s87, s87, 4
    s_cmp_lg_u32 s87, 0
    s_cbranch_scc1 L2_loopO
    s_branch L2_loopF
L2_half:
    v_mfma_f32_32x32x16_bf16 v[64:79], v[56:59], v[144:147], v[64:79]
    v_add_u32 v163, 256, v163
    v_add_u32 v164, 512, v164
    v_add_u32 v165, 64, v165
L2_loopF:
    v_mfma_f32_32x32x16_bf16 v[16:31], v[128:131], v[140:143], 0
    v_exp_f32 v32, v0
    v_exp_f32 v33, v1
    v_exp_f32 v34, v2
    v_smfmac_f32_32x32x32_bf16 v[16:31], v[120:123], v[104:111], v124
    v_exp_f32 v35, v3
    v_exp_f32 v36, v4
    v_exp_f32 v37, v5
    v_mfma_f32_32x32x16_bf16 v[80:95], v[60:63], v[144:147], v[80:95]
    v_exp_f32 v38, v6
    v_exp_f32 v39, v7
    v_exp_f32 v40, v8
    v_exp_f32 v41, v9
    v_exp_f32 v42, v10
    v_exp_f32 v43, v11
    v_exp_f32 v44, v12
    v_exp_f32 v45, v13
    v_exp_f32 v46, v14
    v_exp_f32 v47, v15
    v_pk_add_f32 v[48:49], v[32:33], 1.0 op_sel_hi:[1,0]
    v_pk_add_f32 v[52:53], v[40:41], 1.0 op_sel_hi:[1,0]
    v_pk_fma_f32 v[50:51], v[0:1], v[34:35], v[0:1]
    v_pk_fma_f32 v[54:55], v[8:9], v[42:43], v[8:9]
    v_pk_fma_f32 v[50:51], v[2:3], v[48:49], v[50:51]
    v_pk_fma_f32 v[54:55], v[10:11], v[52:53], v[54:55]
    v_pk_fma_f32 v[48:49], v[48:49], v[34:35], v[48:49]
    v_pk_fma_f32 v[52:53], v[52:53], v[42:43], v[52:53]
    v_pk_fma_f32 v[50:51], v[50:51], v[36:37], v[50:51]
    v_pk_fma_f32 v[54:55], v[54:55], v[44:45], v[54:55]
    v_pk_fma_f32 v[50:51], v[4:5], v[48:49], v[50:51]
    v_pk_fma_f32 v[54:55], v[12:13], v[52:53], v[54:55]
    v_pk_fma_f32 v[48:49], v[48:49], v[36:37], v[48:49]
    s_setprio 1
    v_pk_fma_f32 v[52:53], v[52:53], v[44:45], v[52:53]
    v_pk_fma_f32 v[50:51], v[50:51], v[38:39], v[50:51]
    v_pk_fma_f32 v[54:55], v[54:55], v[46:47], v[54:55]
    v_pk_fma_f32 v[50:51], v[6:7], v[48:49], v[50:51]
    v_pk_fma_f32 v[54:55], v[14:15], v[52:53], v[54:55]
    v_pk_fma_f32 v[48:49], v[48:49], v[38:39], v[48:49]
    v_pk_fma_f32 v[52:53], v[52:53], v[46:47], v[52:53]
    v_rcp_f32 v48, v48
    v_rcp_f32 v49, v49
    v_rcp_f32 v52, v52
    v_rcp_f32 v53, v53
    v_pk_mul_f32 v[50:51], v[50:51], v[48:49]
    v_pk_mul_f32 v[54:55], v[54:55], v[52:53]
    v_cvt_pk_bf16_f32 v56, v50, v51
    v_cvt_pk_bf16_f32 v57, v54, v55
    s_waitcnt lgkmcnt(0)
    v_add_u32 v156, v156, v158
    v_add_u32 v166, 1024, v166
    v_add_u32 v163, 256, v163
    v_add_u32 v164, 512, v164
    v_add_u32 v165, 64, v165
    v_mfma_f32_32x32x16_bf16 v[0:15], v[132:135], v[136:139], 0
    v_exp_f32 v32, v16
    v_exp_f32 v33, v17
    v_exp_f32 v34, v18
    v_smfmac_f32_32x32x32_bf16 v[0:15], v[120:123], v[96:103], v124
    v_exp_f32 v35, v19
    v_exp_f32 v36, v20
    v_exp_f32 v37, v21
    v_exp_f32 v38, v22
    v_exp_f32 v39, v23
    v_exp_f32 v40, v24
    v_exp_f32 v41, v25
    v_exp_f32 v42, v26
    v_exp_f32 v43, v27
    v_exp_f32 v44, v28
    v_exp_f32 v45, v29
    v_exp_f32 v46, v30
    v_exp_f32 v47, v31
    v_pk_add_f32 v[48:49], v[32:33], 1.0 op_sel_hi:[1,0]
    v_pk_add_f32 v[52:53], v[40:41], 1.0 op_sel_hi:[1,0]
    v_pk_fma_f32 v[50:51], v[16:17], v[34:35], v[16:17]
    v_pk_fma_f32 v[54:55], v[24:25], v[42:43], v[24:25]
    v_pk_fma_f32 v[50:51], v[18:19], v[48:49], v[50:51]
    v_pk_fma_f32 v[54:55], v[26:27], v[52:53], v[54:55]
    v_pk_fma_f32 v[48:49], v[48:49], v[34:35], v[48:49]
    v_pk_fma_f32 v[52:53], v[52:53], v[42:43], v[52:53]
    v_pk_fma_f32 v[50:51], v[50:51], v[36:37], v[50:51]
    v_pk_fma_f32 v[54:55], v[54:55], v[44:45], v[54:55]
    v_pk_fma_f32 v[50:51], v[20:21], v[48:49], v[50:51]
    v_pk_fma_f32 v[54:55], v[28:29], v[52:53], v[54:55]
    v_pk_fma_f32 v[48:49], v[48:49], v[36:37], v[48:49]
    v_pk_fma_f32 v[52:53], v[52:53], v[44:45], v[52:53]
    v_pk_fma_f32 v[50:51], v[50:51], v[38:39], v[50:51]
    v_pk_fma_f32 v[54:55], v[54:55], v[46:47], v[54:55]
    v_pk_fma_f32 v[50:51], v[22:23], v[48:49], v[50:51]
    v_pk_fma_f32 v[54:55], v[30:31], v[52:53], v[54:55]
    v_pk_fma_f32 v[48:49], v[48:49], v[38:39], v[48:49]
    v_pk_fma_f32 v[52:53], v[52:53], v[46:47], v[52:53]
    v_rcp_f32 v48, v48
    v_rcp_f32 v49, v49
    v_rcp_f32 v52, v52
    v_rcp_f32 v53, v53
    v_pk_mul_f32 v[50:51], v[50:51], v[48:49]
    v_pk_mul_f32 v[54:55], v[54:55], v[52:53]
    v_cvt_pk_bf16_f32 v60, v50, v51
    v_cvt_pk_bf16_f32 v61, v54, v55
    s_setprio 0
    s_sub_u32 s84, s84, 1
    s_cmp_eq_u32 s84, 0
    s_cbranch_scc1 L2_end_odd
    s_waitcnt vmcnt(4)
    ds_read_b64_tr_b16 v[96:97], v159 offset:0
    ds_read_b64_tr_b16 v[98:99], v159 offset:512
    ds_read_b64_tr_b16 v[100:101], v159 offset:1024
    ds_read_b64_tr_b16 v[102:103], v159 offset:1536
    ds_read_b64_tr_b16 v[104:105], v160 offset:0
    ds_read_b64_tr_b16 v[106:107], v160 offset:512
    ds_read_b64_tr_b16 v[108:109], v160 offset:1024
    ds_read_b64_tr_b16 v[110:111], v160 offset:1536
    ds_read_b64_tr_b16 v[140:141], v157 offset:64
    ds_read_b64_tr_b16 v[136:137], v156
    ds_read2st64_b32 v[130:131], v164 offset0:2 offset1:2
    ds_read_b128 v[144:147], v166
    s_cmp_gt_u32 s84, 3
    s_cselect_b32 s38, 12502, 0
    s_waitcnt lgkmcnt(4)
    s_add_u32 m0, s91, 0
    s_nop 0
    buffer_load_dwordx4 v[148:149], s[36:39], 0 idxen offen lds
    s_add_u32 m0, m0, 1024
    s_nop 0
    buffer_load_dwordx4 v[150:151], s[36:39], 0 idxen offen lds
    s_add_u32 m0, m0, 1024
    s_nop 0
    buffer_load_dwordx4 v[152:153], s[36:39], 0 idxen offen lds
    s_add_u32 m0, m0, 1024
    s_nop 0
    buffer_load_dwordx4 v[154:155], s[36:39], 0 idxen offen lds
    ds_read_b32 v148, v163 offset:640
    ds_read_b32 v150, v163 offset:672
    ds_read_b32 v152, v163 offset:704
    ds_read_b32 v154, v163 offset:736
    ds_read_b32 v157, v165 offset:96
    s_waitcnt lgkmcnt(5)
    v_mfma_f32_32x32x16_bf16 v[16:31], v[132:135], v[140:143], 0
    v_exp_f32 v32, v0
    v_exp_f32 v33, v1
    v_exp_f32 v34, v2
    v_smfmac_f32_32x32x32_bf16 v[16:31], v[120:123], v[112:119], v124
    v_exp_f32 v35, v3
    v_exp_f32 v36, v4
    v_exp_f32 v37, v5
    v_exp_f32 v38, v6
    v_exp_f32 v39, v7
    v_exp_f32 v40, v8
    v_exp_f32 v41, v9
    v_exp_f32 v42, v10
    v_exp_f32 v43, v11
    v_exp_f32 v44, v12
    v_exp_f32 v45, v13
    v_exp_f32 v46, v14
    v_exp_f32 v47, v15
    v_pk_add_f32 v[48:49], v[32:33], 1.0 op_sel_hi:[1,0]
    v_pk_add_f32 v[52:53], v[40:41], 1.0 op_sel_hi:[1,0]
    v_pk_fma_f32 v[50:51], v[0:1], v[34:35], v[0:1]
    v_pk_fma_f32 v[54:55], v[8:9], v[42:43], v[8:9]
    v_pk_fma_f32 v[50:51], v[2:3], v[48:49], v[50:51]
    v_pk_fma_f32 v[54:55], v[10:11], v[52:53], v[54:55]
    v_pk_fma_f32 v[48:49], v[48:49], v[34:35], v[48:49]
    v_pk_fma_f32 v[52:53], v[52:53], v[42:43], v[52:53]
    v_pk_fma_f32 v[50:51], v[50:51], v[36:37], v[50:51]
    v_pk_fma_f32 v[54:55], v[54:55], v[44:45], v[54:55]
    v_pk_fma_f32 v[50:51], v[4:5], v[48:49], v[50:51]
    v_pk_fma_f32 v[54:55], v[12:13], v[52:53], v[54:55]
    v_pk_fma_f32 v[48:49], v[48:49], v[36:37], v[48:49]
    v_pk_fma_f32 v[52:53], v[52:53], v[44:45], v[52:53]
    s_setprio 1
    v_pk_fma_f32 v[50:51], v[50:51], v[38:39], v[50:51]
    v_pk_fma_f32 v[54:55], v[54:55], v[46:47], v[54:55]
    v_pk_fma_f32 v[50:51], v[6:7], v[48:49], v[50:51]
    v_pk_fma_f32 v[54:55], v[14:15], v[52:53], v[54:55]
    v_pk_fma_f32 v[48:49], v[48:49], v[38:39], v[48:49]
    v_pk_fma_f32 v[52:53], v[52:53], v[46:47], v[52:53]
    v_rcp_f32 v48, v48
    v_rcp_f32 v49, v49
    v_rcp_f32 v52, v52
    v_rcp_f32 v53, v53
    v_pk_mul_f32 v[50:51], v[50:51], v[48:49]
    v_pk_mul_f32 v[54:55], v[54:55], v[52:53]
    v_cvt_pk_bf16_f32 v58, v50, v51
    v_cvt_pk_bf16_f32 v59, v54, v55
    s_waitcnt lgkmcnt(0)
    v_add_u32 v157, v157, v158
    v_mfma_f32_32x32x16_bf16 v[0:15], v[128:131], v[136:139], 0
    v_exp_f32 v32, v16
    v_exp_f32 v33, v17
    v_exp_f32 v34, v18
    v_smfmac_f32_32x32x32_bf16 v[0:15], v[120:123], v[96:103], v124
    v_exp_f32 v35, v19
    v_exp_f32 v36, v20
    v_exp_f32 v37, v21
    v_mfma_f32_32x32x16_bf16 v[64:79], v[56:59], v[144:147], v[64:79]
    v_exp_f32 v38, v22
    v_exp_f32 v39, v23
    v_exp_f32 v40, v24
    v_exp_f32 v41, v25
    v_exp_f32 v42, v26
    v_exp_f32 v43, v27
    v_exp_f32 v44, v28
    v_exp_f32 v45, v29
    v_exp_f32 v46, v30
    v_exp_f32 v47, v31
    v_pk_add_f32 v[48:49], v[32:33], 1.0 op_sel_hi:[1,0]
    v_pk_add_f32 v[52:53], v[40:41], 1.0 op_sel_hi:[1,0]
    v_pk_fma_f32 v[50:51], v[16:17], v[34:35], v[16:17]
    v_pk_fma_f32 v[54:55], v[24:25], v[42:43], v[24:25]
    v_pk_fma_f32 v[50:51], v[18:19], v[48:49], v[50:51]
    v_pk_fma_f32 v[54:55], v[26:27], v[52:53], v[54:55]
    v_pk_fma_f32 v[48:49], v[48:49], v[34:35], v[48:49]
    v_pk_fma_f32 v[52:53], v[52:53], v[42:43], v[52:53]
    v_pk_fma_f32 v[50:51], v[50:51], v[36:37], v[50:51]
    v_pk_fma_f32 v[54:55], v[54:55], v[44:45], v[54:55]
    v_pk_fma_f32 v[50:51], v[20:21], v[48:49], v[50:51]
    v_pk_fma_f32 v[54:55], v[28:29], v[52:53], v[54:55]
    v_pk_fma_f32 v[48:49], v[48:49], v[36:37], v[48:49]
    v_pk_fma_f32 v[52:53], v[52:53], v[44:45], v[52:53]
    v_pk_fma_f32 v[50:51], v[50:51], v[38:39], v[50:51]
    v_pk_fma_f32 v[54:55], v[54:55], v[46:47], v[54:55]
    v_pk_fma_f32 v[50:51], v[22:23], v[48:49], v[50:51]
    v_pk_fma_f32 v[54:55], v[30:31], v[52:53], v[54:55]
    v_pk_fma_f32 v[48:49], v[48:49], v[38:39], v[48:49]
    v_pk_fma_f32 v[52:53], v[52:53], v[46:47], v[52:53]
    v_rcp_f32 v48, v48
    v_rcp_f32 v49, v49
    v_rcp_f32 v52, v52
    v_rcp_f32 v53, v53
    v_pk_mul_f32 v[50:51], v[50:51], v[48:49]
    v_pk_mul_f32 v[54:55], v[54:55], v[52:53]
    v_cvt_pk_bf16_f32 v62, v50, v51
    v_cvt_pk_bf16_f32 v63, v54, v55
    s_setprio 0
    s_sub_u32 s84, s84, 1
    s_cmp_eq_u32 s84, 0
    s_cbranch_scc1 L2_end_even
    s_waitcnt vmcnt(4)
    ds_read_b64_tr_b16 v[96:97], v159 offset:4096
    ds_read_b64_tr_b16 v[98:99], v159 offset:4608
    ds_read_b64_tr_b16 v[100:101], v159 offset:5120
    ds_read_b64_tr_b16 v[102:103], v159 offset:5632
    ds_read_b64_tr_b16 v[112:113], v160 offset:4096
    ds_read_b64_tr_b16 v[114:115], v160 offset:4608
    ds_read_b64_tr_b16 v[116:117], v160 offset:5120
    ds_read_b64_tr_b16 v[118:119], v160 offset:5632
    ds_read_b64_tr_b16 v[140:141], v156 offset:64
    ds_read_b64_tr_b16 v[136:137], v157
    ds_read2st64_b32 v[134:135], v164 offset0:3 offset1:3
    s_cmp_gt_u32 s84, 3
    s_cselect_b32 s38, 12502, 0
    s_waitcnt lgkmcnt(3)
    s_add_u32 m0, s91, 4096
    s_nop 0
    buffer_load_dwordx4 v[148:149], s[36:39], 0 idxen offen lds
    s_add_u32 m0, m0, 1024
    s_nop 0
    buffer_load_dwordx4 v[150:151], s[36:39], 0 idxen offen lds
    s_add_u32 m0, m0, 1024
    s_nop 0
    buffer_load_dwordx4 v[152:153], s[36:39], 0 idxen offen lds
    s_add_u32 m0, m0, 1024
    s_nop 0
    buffer_load_dwordx4 v[154:155], s[36:39], 0 idxen offen lds
    ds_read_b32 v148, v163 offset:768
    ds_read_b32 v150, v163 offset:800
    ds_read_b32 v152, v163 offset:832
    ds_read_b32 v154, v163 offset:864
    ds_read_b32 v156, v165 offset:128
    s_waitcnt lgkmcnt(5)
    s_branch L2_loopF
L2_end_odd:
    ds_read_b128 v[144:147], v166
    s_waitcnt lgkmcnt(0)
    v_mfma_f32_32x32x16_bf16 v[64:79], v[56:59], v[144:147], v[64:79]
L2_end_even:
    v_mfma_f32_32x32x16_bf16 v[80:95], v[60:63], v[144:147], v[80:95]
L2_done:
    s_waitcnt vmcnt(0)
    s_cmp_eq_u32 s83, 0
    s_cbranch_scc1 L2_epi
    s_add_u32 s92, s92, 1
    s_lshr_b32 s80, s92, 1
    s_lshl_b32 s80, s80, 3
    s_xor_b32 s82, s82, 15
    s_cmp_ge_u32 s80, s88
    s_cbranch_scc1 L2_epi
    s_barrier
    s_branch L2_batch
L2_epi:
    v_xor_b32 v32, 0, v162
    s_nop 6
    v_cvt_pk_bf16_f32 v16, v64, v65
    v_cvt_pk_bf16_f32 v17, v66, v67
    ds_write_b64 v32, v[16:17]
    v_xor_b32 v33, 16, v162
    v_cvt_pk_bf16_f32 v18, v68, v69
    v_cvt_pk_bf16_f32 v19, v70, v71
    ds_write_b64 v33, v[18:19]
    v_xor_b32 v34, 32, v162
    v_cvt_pk_bf16_f32 v20, v72, v73
    v_cvt_pk_bf16_f32 v21, v74, v75
    ds_write_b64 v34, v[20:21]
    v_xor_b32 v35, 48, v162
    v_cvt_pk_bf16_f32 v22, v76, v77
    v_cvt_pk_bf16_f32 v23, v78, v79
    ds_write_b64 v35, v[22:23]
    v_xor_b32 v36, 64, v162
    v_cvt_pk_bf16_f32 v24, v80, v81
    v_cvt_pk_bf16_f32 v25, v82, v83
    ds_write_b64 v36, v[24:25]
    v_xor_b32 v37, 80, v162
    v_cvt_pk_bf16_f32 v26, v84, v85
    v_cvt_pk_bf16_f32 v27, v86, v87
    ds_write_b64 v37, v[26:27]
    v_xor_b32 v38, 96, v162
    v_cvt_pk_bf16_f32 v28, v88, v89
    v_cvt_pk_bf16_f32 v29, v90, v91
    ds_write_b64 v38, v[28:29]
    v_xor_b32 v39, 112, v162
    v_cvt_pk_bf16_f32 v30, v92, v93
    v_cvt_pk_bf16_f32 v31, v94, v95
    ds_write_b64 v39, v[30:31]
    s_waitcnt lgkmcnt(0)
    s_barrier
    s_branch L2_fin
L2_H:
    v_mov_b32 v160, v125
    v_mov_b32 v163, 0
    v_lshrrev_b32 v3, 4, v160
    v_and_b32 v4, 15, v160
    v_xor_b32 v6, v3, v4
    v_lshlrev_b32 v6, 4, v6
    v_lshl_or_b32 v6, v3, 8, v6
    v_xor_b32 v7, 64, v6
    v_xor_b32 v8, 128, v6
    v_xor_b32 v9, 192, v6
    s_lshl_b32 s97, s26, 12
    s_add_u32 m0, s97, 62208
    s_lshl_b32 s96, s93, 8
    s_add_u32 s96, s96, s97
    v_and_b32 v12, 31, v160
    v_lshlrev_b32 v13, 3, v12
    v_mov_b32 v14, 0
    s_waitcnt lgkmcnt(0)
    s_mov_b32 s40, s4
    s_mov_b32 s41, s5
    s_mov_b32 s42, 3200000
    s_mov_b32 s43, 0x00020000
    buffer_load_dwordx4 v6, s[40:43], s96 offen lds
    s_add_u32 m0, m0, 1024
    s_add_u32 s96, s96, 1024
    buffer_load_dwordx4 v7, s[40:43], s96 offen lds
    s_add_u32 m0, m0, 1024
    s_add_u32 s96, s96, 1024
    buffer_load_dwordx4 v8, s[40:43], s96 offen lds
    s_add_u32 m0, m0, 1024
    s_add_u32 s96, s96, 1024
    buffer_load_dwordx4 v9, s[40:43], s96 offen lds
    s_add_u32 s44, s24, 6473728
    s_addc_u32 s45, s25, 0
    s_mov_b32 s46, 1024
    s_mov_b32 s47, 0x00020000
    s_add_u32 s28, s24, 6543360
    s_addc_u32 s29, s25, 0
    s_mov_b32 s30, 784
    s_mov_b32 s31, 0x00020000
    s_add_u32 s32, s24, 6544384
    s_addc_u32 s33, s25, 0
    s_mov_b32 s34, 1008
    s_mov_b32 s35, 0x00020000
    s_add_u32 s36, s24, 6545408
    s_addc_u32 s37, s25, 0
    s_mov_b32 s38, 4
    s_mov_b32 s39, 0x00020000
    s_lshl_b32 s96, s26, 8
    buffer_load_dwordx2 v[164:165], v13, s[44:47], s96 offen
    buffer_load_dwordx4 v[128:131], v161, s[28:31], 0 offen
    buffer_load_dwordx4 v[132:135], v161, s[32:35], 0 offen
    buffer_load_dword v136, v14, s[36:39], 0 offen
L2_hb:
    s_lshl_b32 s96, s26, 10
    v_add_u32 v144, s96, v161
    v_mov_b32 v148, -1
    v_mov_b32 v152, 0
    v_mov_b32 v149, -1
    v_mov_b32 v153, 0
    v_mov_b32 v150, -1
    v_mov_b32 v154, 0
    v_mov_b32 v151, -1
    v_mov_b32 v155, 0
    ds_write_b128 v144, v[152:155] offset:12544
    ds_write_b128 v144, v[152:155] offset:16640
    ds_write_b128 v144, v[152:155] offset:20736
    ds_write_b128 v144, v[152:155] offset:24832
    ds_write_b128 v144, v[152:155] offset:28928
    ds_write_b128 v144, v[152:155] offset:33024
    ds_write_b128 v144, v[152:155] offset:37120
    ds_write_b128 v144, v[152:155] offset:41216
    ds_write_b128 v144, v[152:155] offset:45312
    ds_write_b128 v144, v[152:155] offset:49408
    ds_write_b128 v144, v[152:155] offset:53504
    ds_write_b128 v144, v[152:155] offset:57600
    ds_write_b128 v144, v[148:151] offset:256
    ds_write_b128 v144, v[148:151] offset:4352
    v_mov_b32 v156, 90432
    v_mov_b32 v157, 90432
    v_mov_b32 v158, 90432
    v_mov_b32 v159, 90432
    v_cmp_gt_u32 vcc, 512, v144
    s_nop 0
    s_and_b64 exec, exec, vcc
    ds_write_b128 v144, v[152:155] offset:61696
    s_mov_b64 exec, -1
    v_cmp_gt_u32 vcc, 2048, v144
    s_nop 0
    s_and_b64 exec, exec, vcc
    ds_write_b128 v144, v[156:159] offset:8448
    s_mov_b64 exec, -1
    s_cmp_eq_u32 s86, 0
    s_cbranch_scc1 L2_hn
    s_setprio 3
    s_waitcnt vmcnt(0)
    v_mov_b32 v140, 1
    v_mov_b32 v141, 0
    v_max3_u32 v128, v128, v129, v130
    v_max3_u32 v132, v132, v133, v134
    v_max_u32 v128, v128, v131
    v_max_u32 v132, v132, v135
    s_nop 0
    v_max_u32_dpp v128, v128, v128 row_shr:1 row_mask:0xf bank_mask:0xf bound_ctrl:0
    v_max_u32_dpp v132, v132, v132 row_shr:1 row_mask:0xf bank_mask:0xf bound_ctrl:0
    s_nop 0
    v_max_u32_dpp v128, v128, v128 row_shr:2 row_mask:0xf bank_mask:0xf bound_ctrl:0
    v_max_u32_dpp v132, v132, v132 row_shr:2 row_mask:0xf bank_mask:0xf bound_ctrl:0
    s_nop 0
    v_max_u32_dpp v128, v128, v128 row_shr:4 row_mask:0xf bank_mask:0xf bound_ctrl:0
    v_max_u32_dpp v132, v132, v132 row_shr:4 row_mask:0xf bank_mask:0xf bound_ctrl:0
    s_nop 0
    v_max_u32_dpp v128, v128, v128 row_shr:8 row_mask:0xf bank_mask:0xf bound_ctrl:0
    v_max_u32_dpp v132, v132, v132 row_shr:8 row_mask:0xf bank_mask:0xf bound_ctrl:0
    s_nop 0
    v_max_u32_dpp v128, v128, v128 row_bcast:15 row_mask:0xa bank_mask:0xf
    v_max_u32_dpp v132, v132, v132 row_bcast:15 row_mask:0xa bank_mask:0xf
    s_nop 0
    v_max_u32_dpp v128, v128, v128 row_bcast:31 row_mask:0xc bank_mask:0xf
    v_max_u32_dpp v132, v132, v132 row_bcast:31 row_mask:0xc bank_mask:0xf
    v_mul_f32 v136, v136, v132
    v_sqrt_f32 v136, v136
    v_mov_b32 v142, 1105199104
    v_add_f32 v136, v128, v136
    v_mov_b32 v143, 1090519040
    v_cmp_nlt_f32 vcc, v136, v142
    v_cmp_nlt_f32 s[94:95], v136, v143
    s_nop 0
    v_cndmask_b32 v142, 0, v140, vcc
    v_cndmask_b32 v143, 0, v140, s[94:95]
    v_cmp_gt_f32 vcc, 1015021568, v136
    v_add_u32 v136, v142, v143
    s_nop 0
    v_cndmask_b32_e64 v136, v136, 2, vcc
    v_and_b32 v137, 31, v160
    v_lshrrev_b32 v138, 5, v160
    v_and_b32 v139, 15, v160
    v_xor_b32 v139, v139, v138
    v_lshlrev_b32 v139, 4, v139
    v_lshl_add_u32 v139, v137, 8, v139
    v_add_u32 v139, 62208, v139
    s_lshl_b32 s96, s26, 7
    s_add_u32 s96, s96, 62208
    v_lshl_add_u32 v166, v137, 2, s96
    v_mul_u32_u24 v138, 2304, v138
    v_add_u32 v166, v166, v138
    s_waitcnt vmcnt(0) lgkmcnt(0)
    s_barrier
    ds_read_b128 v[0:3], v139
    ds_read_b128 v[32:35], v139 offset:8192
    v_xor_b32 v139, 32, v139
    ds_read_b128 v[4:7], v139
    ds_read_b128 v[36:39], v139 offset:8192
    v_xor_b32 v139, 96, v139
    ds_read_b128 v[8:11], v139
    ds_read_b128 v[40:43], v139 offset:8192
    v_xor_b32 v139, 32, v139
    ds_read_b128 v[12:15], v139
    ds_read_b128 v[44:47], v139 offset:8192
    v_xor_b32 v139, 224, v139
    ds_read_b128 v[16:19], v139
    ds_read_b128 v[48:51], v139 offset:8192
    v_xor_b32 v139, 32, v139
    ds_read_b128 v[20:23], v139
    ds_read_b128 v[52:55], v139 offset:8192
    v_xor_b32 v139, 96, v139
    ds_read_b128 v[24:27], v139
    ds_read_b128 v[56:59], v139 offset:8192
    v_xor_b32 v139, 32, v139
    ds_read_b128 v[28:31], v139
    ds_read_b128 v[60:63], v139 offset:8192
    s_mov_b32 exec_lo, 0
    s_mov_b32 exec_hi, 0x80000000
    ds_write_b32 v141, v136 offset:14592
    s_mov_b64 exec, -1
    s_add_u32 s44, s24, 6477824
    s_addc_u32 s45, s25, 0
    s_mov_b32 s46, 65536
    s_mov_b32 s47, 0x00020000
    s_lshl_b32 s96, s26, 14
    s_add_u32 s96, s96, 0
    buffer_load_dwordx4 v[64:67], v161, s[44:47], s96 offen offset:0
    buffer_load_dwordx4 v[68:71], v161, s[44:47], s96 offen offset:1024
    buffer_load_dwordx4 v[72:75], v161, s[44:47], s96 offen offset:2048
    buffer_load_dwordx4 v[76:79], v161, s[44:47], s96 offen offset:3072
    s_add_u32 s96, s96, 4096
    buffer_load_dwordx4 v[80:83], v161, s[44:47], s96 offen offset:0
    buffer_load_dwordx4 v[84:87], v161, s[44:47], s96 offen offset:1024
    buffer_load_dwordx4 v[88:91], v161, s[44:47], s96 offen offset:2048
    buffer_load_dwordx4 v[92:95], v161, s[44:47], s96 offen offset:3072
    s_mov_b32 s28, s24
    s_mov_b32 s29, s25
    s_mov_b32 s30, 6400000
    s_mov_b32 s31, 0x00020000
    s_lshr_b32 s96, s2, 3
    s_lshl_b32 s96, s96, 2
    s_add_u32 s96, s96, s26
    s_mul_i32 s96, s96, 10240
    v_lshlrev_b32 v142, 7, v160
    s_waitcnt lgkmcnt(0)
    s_barrier
    ds_read_b64 v[128:129], v141 offset:14592
    s_mov_b32 s97, s96
    s_add_u32 s44, s24, 6477824
    s_addc_u32 s45, s25, 0
    s_mov_b32 s46, 65536
    s_mov_b32 s47, 0x00020000
    s_lshl_b32 s96, s26, 14
    s_add_u32 s96, s96, 8192
    buffer_load_dwordx4 v[96:99], v161, s[44:47], s96 offen offset:0
    buffer_load_dwordx4 v[100:103], v161, s[44:47], s96 offen offset:1024
    buffer_load_dwordx4 v[104:107], v161, s[44:47], s96 offen offset:2048
    buffer_load_dwordx4 v[108:111], v161, s[44:47], s96 offen offset:3072
    s_add_u32 s96, s96, 4096
    buffer_load_dwordx4 v[112:115], v161, s[44:47], s96 offen offset:0
    buffer_load_dwordx4 v[116:119], v161, s[44:47], s96 offen offset:1024
    buffer_load_dwordx4 v[120:123], v161, s[44:47], s96 offen offset:2048
    buffer_load_dwordx4 v[124:127], v161, s[44:47], s96 offen offset:3072
    s_mov_b32 s96, s97
    s_mov_b32 exec_hi, 255
    buffer_load_dword v167, v142, s[28:31], s96 offen
    s_add_u32 s96, s96, 5120
    buffer_load_dword v167, v142, s[28:31], s96 offen
    s_mov_b32 exec_hi, -1
    s_mov_b32 s94, 3216550459
    s_mov_b32 s86, 0
    v_mov_b32 v162, 1.0
    s_waitcnt vmcnt(10) lgkmcnt(0)
    v_readfirstlane_b32 s89, v128
    v_readfirstlane_b32 s88, v129
    v_mfma_f32_32x32x16_bf16 v[128:143], v[0:3], v[64:67], 0
    v_mfma_f32_32x32x16_bf16 v[128:143], v[4:7], v[68:71], v[128:143]
    v_mfma_f32_32x32x16_bf16 v[128:143], v[8:11], v[72:75], v[128:143]
    v_mfma_f32_32x32x16_bf16 v[128:143], v[12:15], v[76:79], v[128:143]
    v_mfma_f32_32x32x16_bf16 v[128:143], v[16:19], v[80:83], v[128:143]
    v_mfma_f32_32x32x16_bf16 v[128:143], v[20:23], v[84:87], v[128:143]
    v_mfma_f32_32x32x16_bf16 v[128:143], v[24:27], v[88:91], v[128:143]
    v_mfma_f32_32x32x16_bf16 v[128:143], v[28:31], v[92:95], v[128:143]
    s_waitcnt vmcnt(2)
    v_mfma_f32_32x32x16_bf16 v[144:159], v[0:3], v[96:99], 0
    v_mfma_f32_32x32x16_bf16 v[144:159], v[4:7], v[100:103], v[144:159]
    v_mfma_f32_32x32x16_bf16 v[144:159], v[8:11], v[104:107], v[144:159]
    v_mfma_f32_32x32x16_bf16 v[144:159], v[12:15], v[108:111], v[144:159]
    v_mfma_f32_32x32x16_bf16 v[144:159], v[16:19], v[112:115], v[144:159]
    v_mfma_f32_32x32x16_bf16 v[144:159], v[20:23], v[116:119], v[144:159]
    v_mfma_f32_32x32x16_bf16 v[144:159], v[24:27], v[120:123], v[144:159]
    v_mfma_f32_32x32x16_bf16 v[144:159], v[28:31], v[124:127], v[144:159]
    v_mfma_f32_32x32x16_bf16 v[0:15], v[32:35], v[64:67], 0
    v_mfma_f32_32x32x16_bf16 v[0:15], v[36:39], v[68:71], v[0:15]
    v_mfma_f32_32x32x16_bf16 v[0:15], v[40:43], v[72:75], v[0:15]
    v_mfma_f32_32x32x16_bf16 v[0:15], v[44:47], v[76:79], v[0:15]
    v_fma_f32 v128, v128, s94, v164
    s_nop 6
    v_fma_f32 v144, v144, s94, v165
    v_max3_f32 v162, |v128|, |v144|, v162
    v_cvt_pk_bf16_f32 v128, v128, v144
    ds_write_b32 v166, v128 offset:0
    v_fma_f32 v129, v129, s94, v164
    v_fma_f32 v145, v145, s94, v165
    v_mfma_f32_32x32x16_bf16 v[0:15], v[48:51], v[80:83], v[0:15]
    v_max3_f32 v162, |v129|, |v145|, v162
    v_cvt_pk_bf16_f32 v129, v129, v145
    ds_write_b32 v166, v129 offset:576
    v_fma_f32 v130, v130, s94, v164
    v_fma_f32 v146, v146, s94, v165
    v_max3_f32 v162, |v130|, |v146|, v162
    v_cvt_pk_bf16_f32 v130, v130, v146
    v_mfma_f32_32x32x16_bf16 v[0:15], v[52:55], v[84:87], v[0:15]
    ds_write_b32 v166, v130 offset:1152
    v_fma_f32 v131, v131, s94, v164
    v_fma_f32 v147, v147, s94, v165
    v_max3_f32 v162, |v131|, |v147|, v162
    v_cvt_pk_bf16_f32 v131, v131, v147
    ds_write_b32 v166, v131 offset:1728
    v_fma_f32 v132, v132, s94, v164
    v_mfma_f32_32x32x16_bf16 v[0:15], v[56:59], v[88:91], v[0:15]
    v_fma_f32 v148, v148, s94, v165
    v_max3_f32 v162, |v132|, |v148|, v162
    v_cvt_pk_bf16_f32 v132, v132, v148
    ds_write_b32 v166, v132 offset:4608
    v_fma_f32 v133, v133, s94, v164
    v_fma_f32 v149, v149, s94, v165
    v_max3_f32 v162, |v133|, |v149|, v162
    v_mfma_f32_32x32x16_bf16 v[0:15], v[60:63], v[92:95], v[0:15]
    v_cvt_pk_bf16_f32 v133, v133, v149
    ds_write_b32 v166, v133 offset:5184
    v_fma_f32 v134, v134, s94, v164
    v_fma_f32 v150, v150, s94, v165
    v_max3_f32 v162, |v134|, |v150|, v162
    v_cvt_pk_bf16_f32 v134, v134, v150
    ds_write_b32 v166, v134 offset:5760
    v_mfma_f32_32x32x16_bf16 v[16:31], v[32:35], v[96:99], 0
    v_fma_f32 v135, v135, s94, v164
    v_fma_f32 v151, v151, s94, v165
    v_max3_f32 v162, |v135|, |v151|, v162
    v_cvt_pk_bf16_f32 v135, v135, v151
    ds_write_b32 v166, v135 offset:6336
    v_fma_f32 v136, v136, s94, v164
    v_fma_f32 v152, v152, s94, v165
    v_mfma_f32_32x32x16_bf16 v[16:31], v[36:39], v[100:103], v[16:31]
    v_max3_f32 v162, |v136|, |v152|, v162
    v_cvt_pk_bf16_f32 v136, v136, v152
    ds_write_b32 v166, v136 offset:9216
    v_fma_f32 v137, v137, s94, v164
    v_fma_f32 v153, v153, s94, v165
    v_max3_f32 v162, |v137|, |v153|, v162
    v_cvt_pk_bf16_f32 v137, v137, v153
    v_mfma_f32_32x32x16_bf16 v[16:31], v[40:43], v[104:107], v[16:31]
    ds_write_b32 v166, v137 offset:9792
    v_fma_f32 v138, v138, s94, v164
    v_fma_f32 v154, v154, s94, v165
    v_max3_f32 v162, |v138|, |v154|, v162
    v_cvt_pk_bf16_f32 v138, v138, v154
    ds_write_b32 v166, v138 offset:10368
    v_fma_f32 v139, v139, s94, v164
    v_mfma_f32_32x32x16_bf16 v[16:31], v[44:47], v[108:111], v[16:31]
    v_fma_f32 v155, v155, s94, v165
    v_max3_f32 v162, |v139|, |v155|, v162
    v_cvt_pk_bf16_f32 v139, v139, v155
    ds_write_b32 v166, v139 offset:10944
    v_fma_f32 v140, v140, s94, v164
    v_fma_f32 v156, v156, s94, v165
    v_max3_f32 v162, |v140|, |v156|, v162
    v_mfma_f32_32x32x16_bf16 v[16:31], v[48:51], v[112:115], v[16:31]
    v_cvt_pk_bf16_f32 v140, v140, v156
    ds_write_b32 v166, v140 offset:13824
    v_fma_f32 v141, v141, s94, v164
    v_fma_f32 v157, v157, s94, v165
    v_max3_f32 v162, |v141|, |v157|, v162
    v_cvt_pk_bf16_f32 v141, v141, v157
    ds_write_b32 v166, v141 offset:14400
    v_mfma_f32_32x32x16_bf16 v[16:31], v[52:55], v[116:119], v[16:31]
    v_fma_f32 v142, v142, s94, v164
    v_fma_f32 v158, v158, s94, v165
    v_max3_f32 v162, |v142|, |v158|, v162
    v_cvt_pk_bf16_f32 v142, v142, v158
    ds_write_b32 v166, v142 offset:14976
    v_fma_f32 v143, v143, s94, v164
    v_fma_f32 v159, v159, s94, v165
    v_mfma_f32_32x32x16_bf16 v[16:31], v[56:59], v[120:123], v[16:31]
    v_max3_f32 v162, |v143|, |v159|, v162
    v_cvt_pk_bf16_f32 v143, v143, v159
    ds_write_b32 v166, v143 offset:15552
    v_mfma_f32_32x32x16_bf16 v[16:31], v[60:63], v[124:127], v[16:31]
    v_fma_f32 v0, v0, s94, v164
    s_nop 10
    v_fma_f32 v16, v16, s94, v165
    v_max3_f32 v162, |v0|, |v16|, v162
    v_cvt_pk_bf16_f32 v0, v0, v16
    ds_write_b32 v166, v0 offset:18432
    v_fma_f32 v1, v1, s94, v164
    v_fma_f32 v17, v17, s94, v165
    v_max3_f32 v162, |v1|, |v17|, v162
    v_cvt_pk_bf16_f32 v1, v1, v17
    ds_write_b32 v166, v1 offset:19008
    v_fma_f32 v2, v2, s94, v164
    v_fma_f32 v18, v18, s94, v165
    v_max3_f32 v162, |v2|, |v18|, v162
    v_cvt_pk_bf16_f32 v2, v2, v18
    ds_write_b32 v166, v2 offset:19584
    v_fma_f32 v3, v3, s94, v164
    v_fma_f32 v19, v19, s94, v165
    v_max3_f32 v162, |v3|, |v19|, v162
    v_cvt_pk_bf16_f32 v3, v3, v19
    ds_write_b32 v166, v3 offset:20160
    v_fma_f32 v4, v4, s94, v164
    v_fma_f32 v20, v20, s94, v165
    v_max3_f32 v162, |v4|, |v20|, v162
    v_cvt_pk_bf16_f32 v4, v4, v20
    ds_write_b32 v166, v4 offset:23040
    v_fma_f32 v5, v5, s94, v164
    v_fma_f32 v21, v21, s94, v165
    v_max3_f32 v162, |v5|, |v21|, v162
    v_cvt_pk_bf16_f32 v5, v5, v21
    ds_write_b32 v166, v5 offset:23616
    v_fma_f32 v6, v6, s94, v164
    v_fma_f32 v22, v22, s94, v165
    v_max3_f32 v162, |v6|, |v22|, v162
    v_cvt_pk_bf16_f32 v6, v6, v22
    ds_write_b32 v166, v6 offset:24192
    v_fma_f32 v7, v7, s94, v164
    v_fma_f32 v23, v23, s94, v165
    v_max3_f32 v162, |v7|, |v23|, v162
    v_cvt_pk_bf16_f32 v7, v7, v23
    ds_write_b32 v166, v7 offset:24768
    s_mov_b32 exec_hi, 0
    v_fma_f32 v8, v8, s94, v164
    v_fma_f32 v24, v24, s94, v165
    v_max3_f32 v162, |v8|, |v24|, v162
    v_cvt_pk_bf16_f32 v8, v8, v24
    ds_write_b32 v166, v8 offset:27648
    v_mov_b32 v40, 0
    ds_write_b32 v166, v40 offset:28224
    s_mov_b64 exec, -1
    v_mov_b32 v40, 0
    v_mov_b32 v41, 1
    v_cmp_neq_f32 vcc, 1.0, v162
    s_nop 0
    s_cmp_eq_u64 vcc, 0
    s_cbranch_scc1 L2_hx
    ds_write_b32 v40, v41 offset:14600
L2_hx:
    s_branch L2_h2
L2_hn:
    s_waitcnt lgkmcnt(0)
    s_barrier
    s_barrier
L2_h2:
    v_mov_b32 v0, 0
    s_waitcnt lgkmcnt(0)
    s_barrier
    ds_read_b64 v[2:3], v0 offset:14600
    ds_read_b32 v4, v161 offset:12544
    ds_read_b32 v5, v161 offset:13568
    s_waitcnt lgkmcnt(0)
    v_readfirstlane_b32 s96, v2
    v_readfirstlane_b32 s97, v3
    s_cmp_eq_u32 s89, 2
    s_cselect_b32 s96, 0, s96
    s_or_b32 s98, s96, s97
    s_cbranch_scc0 L2_h3
    s_cmp_lg_u32 s96, 0
    s_cselect_b32 s89, 2, s89
    s_cmp_lg_u32 s97, 0
    s_cselect_b32 s83, 1, s83
    s_cselect_b32 s81, 8, s81
    s_cselect_b32 s82, 3, s82
    s_waitcnt vmcnt(0) lgkmcnt(0)
    s_barrier
    s_branch L2_hb
L2_h3:
    v_add3_u32 v163, v163, v4, v5
    s_cmp_eq_u32 s83, 0
    s_cbranch_scc1 L2_h4
    s_add_u32 s92, s92, 1
    s_lshr_b32 s80, s92, 1
    s_lshl_b32 s80, s80, 3
    s_xor_b32 s82, s82, 15
    s_cmp_ge_u32 s80, s88
    s_cbranch_scc1 L2_h4
    s_barrier
    s_branch L2_hb
L2_h4:
    s_setprio 0
    s_add_u32 s44, s24, 6404096
    s_addc_u32 s45, s25, 0
    s_mov_b32 s46, 65536
    s_mov_b32 s47, 0x00020000
    s_lshl_b32 s96, s26, 14
    s_add_u32 s96, s96, 0
    buffer_load_dwordx4 v[64:67], v161, s[44:47], s96 offen offset:0
    s_waitcnt vmcnt(0)
    buffer_load_dwordx4 v[68:71], v161, s[44:47], s96 offen offset:1024
    s_waitcnt vmcnt(0)
    buffer_load_dwordx4 v[72:75], v161, s[44:47], s96 offen offset:2048
    s_waitcnt vmcnt(0)
    buffer_load_dwordx4 v[76:79], v161, s[44:47], s96 offen offset:3072
    s_waitcnt vmcnt(0)
    s_add_u32 s96, s96, 4096
    buffer_load_dwordx4 v[80:83], v161, s[44:47], s96 offen offset:0
    s_waitcnt vmcnt(0)
    buffer_load_dwordx4 v[84:87], v161, s[44:47], s96 offen offset:1024
    s_waitcnt vmcnt(0)
    buffer_load_dwordx4 v[88:91], v161, s[44:47], s96 offen offset:2048
    s_waitcnt vmcnt(0)
    buffer_load_dwordx4 v[92:95], v161, s[44:47], s96 offen offset:3072
    s_waitcnt vmcnt(0)
    s_add_u32 s96, s96, 4096
    buffer_load_dwordx4 v[96:99], v161, s[44:47], s96 offen offset:0
    s_waitcnt vmcnt(0)
    buffer_load_dwordx4 v[100:103], v161, s[44:47], s96 offen offset:1024
    s_waitcnt vmcnt(0)
    buffer_load_dwordx4 v[104:107], v161, s[44:47], s96 offen offset:2048
    s_waitcnt vmcnt(0)
    buffer_load_dwordx4 v[108:111], v161, s[44:47], s96 offen offset:3072
    s_waitcnt vmcnt(0)
    s_add_u32 s96, s96, 4096
    buffer_load_dwordx4 v[112:115], v161, s[44:47], s96 offen offset:0
    s_waitcnt vmcnt(0)
    buffer_load_dwordx4 v[116:119], v161, s[44:47], s96 offen offset:1024
    s_waitcnt vmcnt(0)
    buffer_load_dwordx4 v[120:123], v161, s[44:47], s96 offen offset:2048
    s_waitcnt vmcnt(0)
    buffer_load_dwordx4 v[124:127], v161, s[44:47], s96 offen offset:3072
    s_waitcnt vmcnt(0)
    s_mov_b32 s48, s18
    s_mov_b32 s49, s19
    s_mov_b32 s50, 256
    s_mov_b32 s51, 0x00020000
    v_and_b32 v2, 31, v160
    v_lshlrev_b32 v2, 1, v2
    s_lshl_b32 s96, s26, 6
    buffer_load_ushort v162, v2, s[48:51], s96 offen
    v_cvt_f32_u32 v8, v163
    v_lshlrev_b32 v9, 2, v160
    ds_write_b32 v9, v8 offset:14656
    v_and_b32 v2, 31, v160
    v_lshrrev_b32 v3, 5, v160
    v_bfe_u32 v4, v2, 1, 3
    v_xor_b32 v4, v4, v3
    v_lshlrev_b32 v4, 4, v4
    v_lshl_add_u32 v4, v2, 7, v4
    v_add_u32 v164, 91136, v4
    v_add_u32 v5, 15, v2
    v_and_b32 v5, 31, v5
    v_bfe_u32 v4, v5, 1, 3
    v_xor_b32 v4, v4, v3
    v_lshlrev_b32 v4, 4, v4
    v_lshl_add_u32 v4, v5, 7, v4
    v_add_u32 v165, 123904, v4
    v_lshlrev_b32 v163, 4, v3
    v_lshlrev_b32 v166, 10, v3
    v_and_b32 v4, 1, v2
    v_lshl_add_u32 v166, v4, 8, v166
    v_and_b32 v5, 30, v2
    v_lshl_add_u32 v166, v5, 1, v166
    s_lshl_b32 s96, s26, 6
    v_add_u32 v166, s96, v166
    v_cmp_eq_u32 vcc, 0, v4
    v_mov_b32 v5, 0x07060302
    v_mov_b32 v6, 0x01000504
    v_cndmask_b32 v161, v5, v6, vcc
    s_sub_u32 s96, 12500, s93
    s_min_u32 s96, s96, 49
    s_lshl_b32 s96, s96, 8
    s_lshl_b32 s97, s93, 8
    s_add_u32 s52, s20, s97
    s_addc_u32 s53, s21, 0
    s_mov_b32 s54, s96
    s_mov_b32 s55, 0x00020000
    s_mov_b32 s94, 3207688728
    s_mov_b32 s95, 4096
    s_mov_b32 s96, 8192
    s_mov_b32 s97, 12288
    s_waitcnt vmcnt(0)
    v_lshlrev_b32 v162, 16, v162
    v_mul_f32 v162, 3216550459, v162
    ds_read_b128 v[128:131], v163 offset:14656
    ds_read_b128 v[132:135], v163 offset:14688
    ds_read_b128 v[136:139], v163 offset:14720
    ds_read_b128 v[140:143], v163 offset:14752
    ds_read_b128 v[144:147], v163 offset:14784
    ds_read_b128 v[148:151], v163 offset:14816
    ds_read_b128 v[152:155], v163 offset:14848
    s_waitcnt lgkmcnt(0)
    v_mul_f32 v128, v128, v162
    v_mul_f32 v129, v129, v162
    v_mul_f32 v130, v130, v162
    v_mul_f32 v131, v131, v162
    v_mul_f32 v132, v132, v162
    v_mul_f32 v133, v133, v162
    v_mul_f32 v134, v134, v162
    v_mul_f32 v135, v135, v162
    v_mul_f32 v136, v136, v162
    v_mul_f32 v137, v137, v162
    v_mul_f32 v138, v138, v162
    v_mul_f32 v139, v139, v162
    v_mul_f32 v140, v140, v162
    v_mul_f32 v141, v141, v162
    v_mul_f32 v142, v142, v162
    v_mul_f32 v143, v143, v162
    v_mul_f32 v144, v144, v162
    v_mul_f32 v145, v145, v162
    v_mul_f32 v146, v146, v162
    v_mul_f32 v147, v147, v162
    v_mul_f32 v148, v148, v162
    v_mul_f32 v149, v149, v162
    v_mul_f32 v150, v150, v162
    v_mul_f32 v151, v151, v162
    v_mul_f32 v152, v152, v162
    s_mov_b32 exec_lo, 0
    v_mov_b32 v152, 0
    s_mov_b64 exec, -1
    v_mov_b32 v153, 0
    v_mov_b32 v154, 0
    v_mov_b32 v155, 0
    v_mov_b32 v156, 0
    v_mov_b32 v157, 0
    v_mov_b32 v158, 0
    v_mov_b32 v159, 0
    s_barrier
    ds_read_b128 v[0:3], v164 offset:0
    v_xor_b32 v164, 32, v164
    ds_read_b128 v[4:7], v164 offset:0
    v_xor_b32 v164, 96, v164
    ds_read_b128 v[8:11], v164 offset:0
    v_xor_b32 v164, 32, v164
    ds_read_b128 v[12:15], v164 offset:0
    v_xor_b32 v164, 96, v164
    ds_read_b128 v[16:19], v164 offset:8192
    v_xor_b32 v164, 32, v164
    ds_read_b128 v[20:23], v164 offset:8192
    v_xor_b32 v164, 96, v164
    ds_read_b128 v[24:27], v164 offset:8192
    v_xor_b32 v164, 32, v164
    ds_read_b128 v[28:31], v164 offset:8192
    v_xor_b32 v164, 96, v164
    ds_read_b128 v[32:35], v164 offset:16384
    v_xor_b32 v164, 32, v164
    ds_read_b128 v[36:39], v164 offset:16384
    v_xor_b32 v164, 96, v164
    ds_read_b128 v[40:43], v164 offset:16384
    v_xor_b32 v164, 32, v164
    ds_read_b128 v[44:47], v164 offset:16384
    v_xor_b32 v164, 96, v164
    s_waitcnt lgkmcnt(11)
    v_mfma_f32_32x32x16_bf16 v[128:143], v[0:3], v[64:67], v[128:143]
    ds_read_b128 v[48:51], v164 offset:24576
    v_xor_b32 v164, 32, v164
    s_waitcnt lgkmcnt(11)
    v_mfma_f32_32x32x16_bf16 v[128:143], v[4:7], v[68:71], v[128:143]
    ds_read_b128 v[52:55], v164 offset:24576
    v_xor_b32 v164, 96, v164
    s_waitcnt lgkmcnt(11)
    v_mfma_f32_32x32x16_bf16 v[128:143], v[8:11], v[72:75], v[128:143]
    ds_read_b128 v[56:59], v164 offset:24576
    v_xor_b32 v164, 32, v164
    s_waitcnt lgkmcnt(11)
    v_mfma_f32_32x32x16_bf16 v[128:143], v[12:15], v[76:79], v[128:143]
    ds_read_b128 v[60:63], v164 offset:24576
    v_xor_b32 v164, 96, v164
    s_waitcnt lgkmcnt(11)
    v_mfma_f32_32x32x16_bf16 v[128:143], v[16:19], v[80:83], v[128:143]
    ds_read_b128 v[0:3], v165 offset:0
    v_xor_b32 v165, 32, v165
    s_waitcnt lgkmcnt(11)
    v_mfma_f32_32x32x16_bf16 v[128:143], v[20:23], v[84:87], v[128:143]
    ds_read_b128 v[4:7], v165 offset:0
    v_xor_b32 v165, 96, v165
    s_waitcnt lgkmcnt(11)
    v_mfma_f32_32x32x16_bf16 v[128:143], v[24:27], v[88:91], v[128:143]
    ds_read_b128 v[8:11], v165 offset:0
    v_xor_b32 v165, 32, v165
    s_waitcnt lgkmcnt(11)
    v_mfma_f32_32x32x16_bf16 v[128:143], v[28:31], v[92:95], v[128:143]
    ds_read_b128 v[12:15], v165 offset:0
    v_xor_b32 v165, 96, v165
    s_waitcnt lgkmcnt(11)
    v_mfma_f32_32x32x16_bf16 v[128:143], v[32:35], v[96:99], v[128:143]
    ds_read_b128 v[16:19], v165 offset:8192
    v_xor_b32 v165, 32, v165
    s_waitcnt lgkmcnt(11)
    v_mfma_f32_32x32x16_bf16 v[128:143], v[36:39], v[100:103], v[128:143]
    ds_read_b128 v[20:23], v165 offset:8192
    v_xor_b32 v165, 96, v165
    s_waitcnt lgkmcnt(11)
    v_mfma_f32_32x32x16_bf16 v[128:143], v[40:43], v[104:107], v[128:143]
    ds_read_b128 v[24:27], v165 offset:8192
    v_xor_b32 v165, 32, v165
    s_waitcnt lgkmcnt(11)
    v_mfma_f32_32x32x16_bf16 v[128:143], v[44:47], v[108:111], v[128:143]
    ds_read_b128 v[28:31], v165 offset:8192
    v_xor_b32 v165, 96, v165
    s_waitcnt lgkmcnt(11)
    v_mfma_f32_32x32x16_bf16 v[128:143], v[48:51], v[112:115], v[128:143]
    ds_read_b128 v[32:35], v165 offset:16384
    v_xor_b32 v165, 32, v165
    s_waitcnt lgkmcnt(11)
    v_mfma_f32_32x32x16_bf16 v[128:143], v[52:55], v[116:119], v[128:143]
    ds_read_b128 v[36:39], v165 offset:16384
    v_xor_b32 v165, 96, v165
    s_waitcnt lgkmcnt(11)
    v_mfma_f32_32x32x16_bf16 v[128:143], v[56:59], v[120:123], v[128:143]
    ds_read_b128 v[40:43], v165 offset:16384
    v_xor_b32 v165, 32, v165
    s_waitcnt lgkmcnt(11)
    v_mfma_f32_32x32x16_bf16 v[128:143], v[60:63], v[124:127], v[128:143]
    ds_read_b128 v[44:47], v165 offset:16384
    v_xor_b32 v165, 96, v165
    s_waitcnt lgkmcnt(11)
    v_mfma_f32_32x32x16_bf16 v[144:159], v[0:3], v[64:67], v[144:159]
    ds_read_b128 v[48:51], v165 offset:24576
    v_xor_b32 v165, 32, v165
    s_waitcnt lgkmcnt(11)
    v_mfma_f32_32x32x16_bf16 v[144:159], v[4:7], v[68:71], v[144:159]
    ds_read_b128 v[52:55], v165 offset:24576
    v_xor_b32 v165, 96, v165
    s_waitcnt lgkmcnt(11)
    v_mfma_f32_32x32x16_bf16 v[144:159], v[8:11], v[72:75], v[144:159]
    ds_read_b128 v[56:59], v165 offset:24576
    v_xor_b32 v165, 32, v165
    s_waitcnt lgkmcnt(11)
    v_mfma_f32_32x32x16_bf16 v[144:159], v[12:15], v[76:79], v[144:159]
    ds_read_b128 v[60:63], v165 offset:24576
    v_xor_b32 v165, 96, v165
    s_waitcnt lgkmcnt(11)
    v_mfma_f32_32x32x16_bf16 v[144:159], v[16:19], v[80:83], v[144:159]
    s_waitcnt lgkmcnt(10)
    v_mfma_f32_32x32x16_bf16 v[144:159], v[20:23], v[84:87], v[144:159]
    s_waitcnt lgkmcnt(9)
    v_mfma_f32_32x32x16_bf16 v[144:159], v[24:27], v[88:91], v[144:159]
    v_mul_f32 v128, s94, v128
    v_mul_f32 v129, s94, v129
    v_mul_f32 v130, s94, v130
    v_mul_f32 v131, s94, v131
    s_waitcnt lgkmcnt(8)
    v_mfma_f32_32x32x16_bf16 v[144:159], v[28:31], v[92:95], v[144:159]
    v_mul_f32 v132, s94, v132
    v_mul_f32 v133, s94, v133
    v_mul_f32 v134, s94, v134
    v_mul_f32 v135, s94, v135
    s_waitcnt lgkmcnt(7)
    v_mfma_f32_32x32x16_bf16 v[144:159], v[32:35], v[96:99], v[144:159]
    v_cvt_pk_bf16_f32 v0, v128, v129
    v_cvt_pk_bf16_f32 v1, v130, v131
    v_cvt_pk_bf16_f32 v2, v132, v133
    v_cvt_pk_bf16_f32 v3, v134, v135
    s_waitcnt lgkmcnt(6)
    v_mfma_f32_32x32x16_bf16 v[144:159], v[36:39], v[100:103], v[144:159]
    v_mov_b32_dpp v8, v0 quad_perm:[1,0,3,2] row_mask:0xf bank_mask:0xf
    v_mov_b32_dpp v9, v1 quad_perm:[1,0,3,2] row_mask:0xf bank_mask:0xf
    v_mov_b32_dpp v10, v2 quad_perm:[1,0,3,2] row_mask:0xf bank_mask:0xf
    v_mov_b32_dpp v11, v3 quad_perm:[1,0,3,2] row_mask:0xf bank_mask:0xf
    s_waitcnt lgkmcnt(5)
    v_mfma_f32_32x32x16_bf16 v[144:159], v[40:43], v[104:107], v[144:159]
    v_perm_b32 v0, v0, v8, v161
    v_perm_b32 v1, v1, v9, v161
    v_perm_b32 v2, v2, v10, v161
    v_perm_b32 v3, v3, v11, v161
    s_waitcnt lgkmcnt(4)
    v_mfma_f32_32x32x16_bf16 v[144:159], v[44:47], v[108:111], v[144:159]
    buffer_store_dword v0, v166, s[52:55], 0 offen offset:0 sc1
    buffer_store_dword v1, v166, s[52:55], 0 offen offset:512 sc1
    buffer_store_dword v2, v166, s[52:55], 0 offen offset:2048 sc1
    buffer_store_dword v3, v166, s[52:55], 0 offen offset:2560 sc1
    s_waitcnt lgkmcnt(3)
    v_mfma_f32_32x32x16_bf16 v[144:159], v[48:51], v[112:115], v[144:159]
    s_waitcnt lgkmcnt(2)
    v_mfma_f32_32x32x16_bf16 v[144:159], v[52:55], v[116:119], v[144:159]
    s_waitcnt lgkmcnt(1)
    v_mfma_f32_32x32x16_bf16 v[144:159], v[56:59], v[120:123], v[144:159]
    s_waitcnt lgkmcnt(0)
    v_mfma_f32_32x32x16_bf16 v[144:159], v[60:63], v[124:127], v[144:159]
    s_mov_b32 exec_lo, 0
    s_nop 10
    v_add_f32 v136, v136, v152
    s_mov_b64 exec, -1
    v_add_f32 v137, v137, v153
    v_add_f32 v138, v138, v154
    v_add_f32 v139, v139, v155
    v_add_f32 v140, v140, v156
    v_add_f32 v141, v141, v157
    v_add_f32 v142, v142, v158
    v_add_f32 v143, v143, v159
    v_mul_f32 v136, s94, v136
    v_mul_f32 v137, s94, v137
    v_mul_f32 v138, s94, v138
    v_mul_f32 v139, s94, v139
    v_mul_f32 v140, s94, v140
    v_mul_f32 v141, s94, v141
    v_mul_f32 v142, s94, v142
    v_mul_f32 v143, s94, v143
    v_cvt_pk_bf16_f32 v4, v136, v137
    v_cvt_pk_bf16_f32 v5, v138, v139
    v_cvt_pk_bf16_f32 v6, v140, v141
    v_cvt_pk_bf16_f32 v7, v142, v143
    v_mov_b32_dpp v12, v4 quad_perm:[1,0,3,2] row_mask:0xf bank_mask:0xf
    v_mov_b32_dpp v13, v5 quad_perm:[1,0,3,2] row_mask:0xf bank_mask:0xf
    v_mov_b32_dpp v14, v6 quad_perm:[1,0,3,2] row_mask:0xf bank_mask:0xf
    v_mov_b32_dpp v15, v7 quad_perm:[1,0,3,2] row_mask:0xf bank_mask:0xf
    v_perm_b32 v4, v4, v12, v161
    v_perm_b32 v5, v5, v13, v161
    v_perm_b32 v6, v6, v14, v161
    v_perm_b32 v7, v7, v15, v161
    buffer_store_dword v4, v166, s[52:55], s95 offen offset:0 sc1
    buffer_store_dword v5, v166, s[52:55], s95 offen offset:512 sc1
    buffer_store_dword v6, v166, s[52:55], s95 offen offset:2048 sc1
    buffer_store_dword v7, v166, s[52:55], s95 offen offset:2560 sc1
    v_mul_f32 v144, s94, v144
    v_mul_f32 v145, s94, v145
    v_mul_f32 v146, s94, v146
    v_mul_f32 v147, s94, v147
    v_mul_f32 v148, s94, v148
    v_mul_f32 v149, s94, v149
    v_mul_f32 v150, s94, v150
    v_mul_f32 v151, s94, v151
    v_mul_f32 v152, s94, v152
    v_mul_f32 v153, s94, v153
    v_cvt_pk_bf16_f32 v16, v144, v145
    v_cvt_pk_bf16_f32 v17, v146, v147
    v_cvt_pk_bf16_f32 v18, v148, v149
    v_cvt_pk_bf16_f32 v19, v150, v151
    v_cvt_pk_bf16_f32 v20, v152, v153
    v_mov_b32_dpp v24, v16 quad_perm:[1,0,3,2] row_mask:0xf bank_mask:0xf
    v_mov_b32_dpp v25, v17 quad_perm:[1,0,3,2] row_mask:0xf bank_mask:0xf
    v_mov_b32_dpp v26, v18 quad_perm:[1,0,3,2] row_mask:0xf bank_mask:0xf
    v_mov_b32_dpp v27, v19 quad_perm:[1,0,3,2] row_mask:0xf bank_mask:0xf
    v_mov_b32_dpp v28, v20 quad_perm:[1,0,3,2] row_mask:0xf bank_mask:0xf
    v_perm_b32 v16, v16, v24, v161
    v_perm_b32 v17, v17, v25, v161
    v_perm_b32 v18, v18, v26, v161
    v_perm_b32 v19, v19, v27, v161
    v_perm_b32 v20, v20, v28, v161
    buffer_store_dword v16, v166, s[52:55], s96 offen offset:0 sc1
    buffer_store_dword v17, v166, s[52:55], s96 offen offset:512 sc1
    buffer_store_dword v18, v166, s[52:55], s96 offen offset:2048 sc1
    buffer_store_dword v19, v166, s[52:55], s96 offen offset:2560 sc1
    buffer_store_dword v20, v166, s[52:55], s97 offen offset:0 sc1
L2_fin:
L2_exit2:
    s_endpgm
L2_x0:
    s_mov_b64 exec, s[72:73]
    s_cbranch_execz L2_r8
    buffer_load_dwordx3 v[32:34], v108, s[32:35], 0 offen offset:192
L2_r8:
    s_mov_b64 exec, s[74:75]
    s_cbranch_execz L2_r9
    buffer_load_dwordx3 v[36:38], v109, s[32:35], 0 offen offset:192
L2_r9:
    s_mov_b64 exec, s[76:77]
    s_cbranch_execz L2_r10
    buffer_load_dwordx3 v[40:42], v110, s[32:35], 0 offen offset:192
L2_r10:
    s_mov_b64 exec, s[78:79]
    s_cbranch_execz L2_r11
    buffer_load_dwordx3 v[44:46], v111, s[32:35], 0 offen offset:192
L2_r11:
    s_mov_b64 exec, -1
    s_branch L2_x0_r
L2_x2:
    s_mov_b64 exec, s[72:73]
    v_lshrrev_b32 v104, 14, v34
    ds_add_rtn_u32 v35, v104, v62 offset:12544
    s_mov_b64 exec, s[74:75]
    v_lshrrev_b32 v105, 14, v38
    ds_add_rtn_u32 v39, v105, v62 offset:12544
    s_mov_b64 exec, s[76:77]
    v_lshrrev_b32 v106, 14, v42
    ds_add_rtn_u32 v43, v106, v62 offset:12544
    s_mov_b64 exec, s[78:79]
    v_lshrrev_b32 v107, 14, v46
    ds_add_rtn_u32 v47, v107, v62 offset:12544
    s_branch L2_x2_r
L2_x4:
    s_mov_b64 exec, s[72:73]
    v_lshrrev_b32 v96, 14, v34
    ds_read_b128 v[104:107], v96 offset:10496
    s_mov_b64 exec, s[74:75]
    v_lshrrev_b32 v97, 14, v38
    ds_read_b128 v[108:111], v97 offset:10496
    s_mov_b64 exec, s[76:77]
    v_lshrrev_b32 v98, 14, v42
    ds_read_b128 v[112:115], v98 offset:10496
    s_mov_b64 exec, s[78:79]
    v_lshrrev_b32 v99, 14, v46
    ds_read_b128 v[116:119], v99 offset:10496
    s_mov_b64 exec, -1
    s_waitcnt lgkmcnt(0)
    v_cmp_lt_u32_sdwa s[16:17], v35, v104 src0_sel:DWORD src1_sel:WORD_1
    v_cmp_lt_u32_sdwa s[18:19], v35, v104 src0_sel:DWORD src1_sel:WORD_0
    v_cmp_lt_u32_sdwa s[94:95], v39, v108 src0_sel:DWORD src1_sel:WORD_1
    v_cmp_lt_u32_sdwa s[96:97], v39, v108 src0_sel:DWORD src1_sel:WORD_0
    v_cndmask_b32 v107, v107, v106, s[16:17]
    v_cndmask_b32 v107, v107, v105, s[18:19]
    v_and_b32 v34, 16383, v34
    v_add_lshl_u32 v107, v107, v35, 2
    v_lshlrev_b32 v104, 1, v107
    v_cmp_lt_u32_sdwa s[12:13], v43, v112 src0_sel:DWORD src1_sel:WORD_1
    v_cmp_lt_u32_sdwa s[14:15], v43, v112 src0_sel:DWORD src1_sel:WORD_0
    v_cndmask_b32 v111, v111, v110, s[94:95]
    v_cndmask_b32 v111, v111, v109, s[96:97]
    v_and_b32 v38, 16383, v38
    v_add_lshl_u32 v111, v111, v39, 2
    v_lshlrev_b32 v108, 1, v111
    v_cmp_lt_u32_sdwa s[16:17], v47, v116 src0_sel:DWORD src1_sel:WORD_1
    v_cmp_lt_u32_sdwa s[18:19], v47, v116 src0_sel:DWORD src1_sel:WORD_0
    v_cndmask_b32 v115, v115, v114, s[12:13]
    v_cndmask_b32 v115, v115, v113, s[14:15]
    v_and_b32 v42, 16383, v42
    v_add_lshl_u32 v115, v115, v43, 2
    v_lshlrev_b32 v112, 1, v115
    v_cndmask_b32 v119, v119, v118, s[16:17]
    v_cndmask_b32 v119, v119, v117, s[18:19]
    v_and_b32 v46, 16383, v46
    v_add_lshl_u32 v119, v119, v47, 2
    v_lshlrev_b32 v116, 1, v119
    s_mov_b64 exec, s[72:73]
    ds_write_b32 v107, v34 offset:256
    ds_write_b64 v104, v[32:33] offset:15104
    s_mov_b64 exec, s[74:75]
    ds_write_b32 v111, v38 offset:256
    ds_write_b64 v108, v[36:37] offset:15104
    s_mov_b64 exec, s[76:77]
    ds_write_b32 v115, v42 offset:256
    ds_write_b64 v112, v[40:41] offset:15104
    s_mov_b64 exec, s[78:79]
    ds_write_b32 v119, v46 offset:256
    ds_write_b64 v116, v[44:45] offset:15104
    s_branch L2_x4_r
L2_loopS:
    v_mfma_f32_32x32x16_bf16 v[16:31], v[128:131], v[140:143], 0
    v_exp_f32 v32, v0
    v_exp_f32 v33, v1
    v_exp_f32 v34, v2
    v_smfmac_f32_32x32x32_bf16 v[16:31], v[120:123], v[104:111], v124
    v_exp_f32 v35, v3
    v_exp_f32 v36, v4
    v_exp_f32 v37, v5
    v_mfma_f32_32x32x16_bf16 v[80:95], v[60:63], v[144:147], v[80:95]
    v_exp_f32 v38, v6
    v_exp_f32 v39, v7
    v_exp_f32 v40, v8
    v_exp_f32 v41, v9
    v_exp_f32 v42, v10
    v_exp_f32 v43, v11
    v_exp_f32 v44, v12
    v_exp_f32 v45, v13
    v_exp_f32 v46, v14
    v_exp_f32 v47, v15
    v_pk_add_f32 v[32:33], v[32:33], 1.0 op_sel_hi:[1,0]
    v_pk_add_f32 v[34:35], v[34:35], 1.0 op_sel_hi:[1,0]
    v_pk_add_f32 v[36:37], v[36:37], 1.0 op_sel_hi:[1,0]
    v_pk_add_f32 v[38:39], v[38:39], 1.0 op_sel_hi:[1,0]
    v_pk_add_f32 v[40:41], v[40:41], 1.0 op_sel_hi:[1,0]
    v_pk_add_f32 v[42:43], v[42:43], 1.0 op_sel_hi:[1,0]
    v_pk_add_f32 v[44:45], v[44:45], 1.0 op_sel_hi:[1,0]
    v_pk_add_f32 v[46:47], v[46:47], 1.0 op_sel_hi:[1,0]
    v_rcp_f32 v32, v32
    v_rcp_f32 v33, v33
    v_rcp_f32 v34, v34
    v_rcp_f32 v35, v35
    v_rcp_f32 v36, v36
    s_setprio 1
    v_rcp_f32 v37, v37
    v_rcp_f32 v38, v38
    v_rcp_f32 v39, v39
    v_rcp_f32 v40, v40
    v_rcp_f32 v41, v41
    v_rcp_f32 v42, v42
    v_rcp_f32 v43, v43
    v_rcp_f32 v44, v44
    v_rcp_f32 v45, v45
    v_rcp_f32 v46, v46
    v_rcp_f32 v47, v47
    v_pk_mul_f32 v[50:51], v[0:1], v[32:33]
    v_pk_mul_f32 v[54:55], v[8:9], v[40:41]
    v_pk_fma_f32 v[50:51], v[2:3], v[34:35], v[50:51]
    v_pk_fma_f32 v[54:55], v[10:11], v[42:43], v[54:55]
    v_pk_fma_f32 v[50:51], v[4:5], v[36:37], v[50:51]
    v_pk_fma_f32 v[54:55], v[12:13], v[44:45], v[54:55]
    v_pk_fma_f32 v[50:51], v[6:7], v[38:39], v[50:51]
    v_pk_fma_f32 v[54:55], v[14:15], v[46:47], v[54:55]
    v_cvt_pk_bf16_f32 v56, v50, v51
    v_cvt_pk_bf16_f32 v57, v54, v55
    s_waitcnt lgkmcnt(0)
    v_add_u32 v156, v156, v158
    v_add_u32 v166, 1024, v166
    v_add_u32 v163, 256, v163
    v_add_u32 v164, 512, v164
    v_add_u32 v165, 64, v165
    v_mfma_f32_32x32x16_bf16 v[0:15], v[132:135], v[136:139], 0
    v_exp_f32 v32, v16
    v_exp_f32 v33, v17
    v_exp_f32 v34, v18
    v_smfmac_f32_32x32x32_bf16 v[0:15], v[120:123], v[96:103], v124
    v_exp_f32 v35, v19
    v_exp_f32 v36, v20
    v_exp_f32 v37, v21
    v_exp_f32 v38, v22
    v_exp_f32 v39, v23
    v_exp_f32 v40, v24
    v_exp_f32 v41, v25
    v_exp_f32 v42, v26
    v_exp_f32 v43, v27
    v_exp_f32 v44, v28
    v_exp_f32 v45, v29
    v_exp_f32 v46, v30
    v_exp_f32 v47, v31
    v_pk_add_f32 v[32:33], v[32:33], 1.0 op_sel_hi:[1,0]
    v_pk_add_f32 v[34:35], v[34:35], 1.0 op_sel_hi:[1,0]
    v_pk_add_f32 v[36:37], v[36:37], 1.0 op_sel_hi:[1,0]
    v_pk_add_f32 v[38:39], v[38:39], 1.0 op_sel_hi:[1,0]
    v_pk_add_f32 v[40:41], v[40:41], 1.0 op_sel_hi:[1,0]
    v_pk_add_f32 v[42:43], v[42:43], 1.0 op_sel_hi:[1,0]
    v_pk_add_f32 v[44:45], v[44:45], 1.0 op_sel_hi:[1,0]
    v_pk_add_f32 v[46:47], v[46:47], 1.0 op_sel_hi:[1,0]
    v_rcp_f32 v32, v32
    v_rcp_f32 v33, v33
    v_rcp_f32 v34, v34
    v_rcp_f32 v35, v35
    v_rcp_f32 v36, v36
    v_rcp_f32 v37, v37
    v_rcp_f32 v38, v38
    v_rcp_f32 v39, v39
    v_rcp_f32 v40, v40
    v_rcp_f32 v41, v41
    v_rcp_f32 v42, v42
    v_rcp_f32 v43, v43
    v_rcp_f32 v44, v44
    v_rcp_f32 v45, v45
    v_rcp_f32 v46, v46
    v_rcp_f32 v47, v47
    v_pk_mul_f32 v[50:51], v[16:17], v[32:33]
    v_pk_mul_f32 v[54:55], v[24:25], v[40:41]
    v_pk_fma_f32 v[50:51], v[18:19], v[34:35], v[50:51]
    v_pk_fma_f32 v[54:55], v[26:27], v[42:43], v[54:55]
    v_pk_fma_f32 v[50:51], v[20:21], v[36:37], v[50:51]
    v_pk_fma_f32 v[54:55], v[28:29], v[44:45], v[54:55]
    v_pk_fma_f32 v[50:51], v[22:23], v[38:39], v[50:51]
    v_pk_fma_f32 v[54:55], v[30:31], v[46:47], v[54:55]
    v_cvt_pk_bf16_f32 v60, v50, v51
    v_cvt_pk_bf16_f32 v61, v54, v55
    s_setprio 0
    s_sub_u32 s84, s84, 1
    s_cmp_eq_u32 s84, 0
    s_cbranch_scc1 L2_end_odd
    s_waitcnt vmcnt(4)
    ds_read_b64_tr_b16 v[96:97], v159 offset:0
    ds_read_b64_tr_b16 v[98:99], v159 offset:512
    ds_read_b64_tr_b16 v[100:101], v159 offset:1024
    ds_read_b64_tr_b16 v[102:103], v159 offset:1536
    ds_read_b64_tr_b16 v[104:105], v160 offset:0
    ds_read_b64_tr_b16 v[106:107], v160 offset:512
    ds_read_b64_tr_b16 v[108:109], v160 offset:1024
    ds_read_b64_tr_b16 v[110:111], v160 offset:1536
    ds_read_b64_tr_b16 v[140:141], v157 offset:64
    ds_read_b64_tr_b16 v[136:137], v156
    ds_read2st64_b32 v[130:131], v164 offset0:2 offset1:2
    ds_read_b128 v[144:147], v166
    s_cmp_gt_u32 s84, 3
    s_cselect_b32 s38, 12502, 0
    s_waitcnt lgkmcnt(4)
    s_add_u32 m0, s91, 0
    s_nop 0
    buffer_load_dwordx4 v[148:149], s[36:39], 0 idxen offen lds
    s_add_u32 m0, m0, 1024
    s_nop 0
    buffer_load_dwordx4 v[150:151], s[36:39], 0 idxen offen lds
    s_add_u32 m0, m0, 1024
    s_nop 0
    buffer_load_dwordx4 v[152:153], s[36:39], 0 idxen offen lds
    s_add_u32 m0, m0, 1024
    s_nop 0
    buffer_load_dwordx4 v[154:155], s[36:39], 0 idxen offen lds
    ds_read_b32 v148, v163 offset:640
    ds_read_b32 v150, v163 offset:672
    ds_read_b32 v152, v163 offset:704
    ds_read_b32 v154, v163 offset:736
    ds_read_b32 v157, v165 offset:96
    s_waitcnt lgkmcnt(5)
    v_mfma_f32_32x32x16_bf16 v[16:31], v[132:135], v[140:143], 0
    v_exp_f32 v32, v0
    v_exp_f32 v33, v1
    v_exp_f32 v34, v2
    v_smfmac_f32_32x32x32_bf16 v[16:31], v[120:123], v[112:119], v124
    v_exp_f32 v35, v3
    v_exp_f32 v36, v4
    v_exp_f32 v37, v5
    v_exp_f32 v38, v6
    v_exp_f32 v39, v7
    v_exp_f32 v40, v8
    v_exp_f32 v41, v9
    v_exp_f32 v42, v10
    v_exp_f32 v43, v11
    v_exp_f32 v44, v12
    v_exp_f32 v45, v13
    v_exp_f32 v46, v14
    v_exp_f32 v47, v15
    v_pk_add_f32 v[32:33], v[32:33], 1.0 op_sel_hi:[1,0]
    v_pk_add_f32 v[34:35], v[34:35], 1.0 op_sel_hi:[1,0]
    v_pk_add_f32 v[36:37], v[36:37], 1.0 op_sel_hi:[1,0]
    v_pk_add_f32 v[38:39], v[38:39], 1.0 op_sel_hi:[1,0]
    v_pk_add_f32 v[40:41], v[40:41], 1.0 op_sel_hi:[1,0]
    v_pk_add_f32 v[42:43], v[42:43], 1.0 op_sel_hi:[1,0]
    v_pk_add_f32 v[44:45], v[44:45], 1.0 op_sel_hi:[1,0]
    v_pk_add_f32 v[46:47], v[46:47], 1.0 op_sel_hi:[1,0]
    v_rcp_f32 v32, v32
    v_rcp_f32 v33, v33
    v_rcp_f32 v34, v34
    v_rcp_f32 v35, v35
    v_rcp_f32 v36, v36
    v_rcp_f32 v37, v37
    s_setprio 1
    v_rcp_f32 v38, v38
    v_rcp_f32 v39, v39
    v_rcp_f32 v40, v40
    v_rcp_f32 v41, v41
    v_rcp_f32 v42, v42
    v_rcp_f32 v43, v43
    v_rcp_f32 v44, v44
    v_rcp_f32 v45, v45
    v_rcp_f32 v46, v46
    v_rcp_f32 v47, v47
    v_pk_mul_f32 v[50:51], v[0:1], v[32:33]
    v_pk_mul_f32 v[54:55], v[8:9], v[40:41]
    v_pk_fma_f32 v[50:51], v[2:3], v[34:35], v[50:51]
    v_pk_fma_f32 v[54:55], v[10:11], v[42:43], v[54:55]
    v_pk_fma_f32 v[50:51], v[4:5], v[36:37], v[50:51]
    v_pk_fma_f32 v[54:55], v[12:13], v[44:45], v[54:55]
    v_pk_fma_f32 v[50:51], v[6:7], v[38:39], v[50:51]
    v_pk_fma_f32 v[54:55], v[14:15], v[46:47], v[54:55]
    v_cvt_pk_bf16_f32 v58, v50, v51
    v_cvt_pk_bf16_f32 v59, v54, v55
    s_waitcnt lgkmcnt(0)
    v_add_u32 v157, v157, v158
    v_mfma_f32_32x32x16_bf16 v[0:15], v[128:131], v[136:139], 0
    v_exp_f32 v32, v16
    v_exp_f32 v33, v17
    v_exp_f32 v34, v18
    v_smfmac_f32_32x32x32_bf16 v[0:15], v[120:123], v[96:103], v124
    v_exp_f32 v35, v19
    v_exp_f32 v36, v20
    v_exp_f32 v37, v21
    v_mfma_f32_32x32x16_bf16 v[64:79], v[56:59], v[144:147], v[64:79]
    v_exp_f32 v38, v22
    v_exp_f32 v39, v23
    v_exp_f32 v40, v24
    v_exp_f32 v41, v25
    v_exp_f32 v42, v26
    v_exp_f32 v43, v27
    v_exp_f32 v44, v28
    v_exp_f32 v45, v29
    v_exp_f32 v46, v30
    v_exp_f32 v47, v31
    v_pk_add_f32 v[32:33], v[32:33], 1.0 op_sel_hi:[1,0]
    v_pk_add_f32 v[34:35], v[34:35], 1.0 op_sel_hi:[1,0]
    v_pk_add_f32 v[36:37], v[36:37], 1.0 op_sel_hi:[1,0]
    v_pk_add_f32 v[38:39], v[38:39], 1.0 op_sel_hi:[1,0]
    v_pk_add_f32 v[40:41], v[40:41], 1.0 op_sel_hi:[1,0]
    v_pk_add_f32 v[42:43], v[42:43], 1.0 op_sel_hi:[1,0]
    v_pk_add_f32 v[44:45], v[44:45], 1.0 op_sel_hi:[1,0]
    v_pk_add_f32 v[46:47], v[46:47], 1.0 op_sel_hi:[1,0]
    v_rcp_f32 v32, v32
    v_rcp_f32 v33, v33
    v_rcp_f32 v34, v34
    v_rcp_f32 v35, v35
    v_rcp_f32 v36, v36
    v_rcp_f32 v37, v37
    v_rcp_f32 v38, v38
    v_rcp_f32 v39, v39
    v_rcp_f32 v40, v40
    v_rcp_f32 v41, v41
    v_rcp_f32 v42, v42
    v_rcp_f32 v43, v43
    v_rcp_f32 v44, v44
    v_rcp_f32 v45, v45
    v_rcp_f32 v46, v46
    v_rcp_f32 v47, v47
    v_pk_mul_f32 v[50:51], v[16:17], v[32:33]
    v_pk_mul_f32 v[54:55], v[24:25], v[40:41]
    v_pk_fma_f32 v[50:51], v[18:19], v[34:35], v[50:51]
    v_pk_fma_f32 v[54:55], v[26:27], v[42:43], v[54:55]
    v_pk_fma_f32 v[50:51], v[20:21], v[36:37], v[50:51]
    v_pk_fma_f32 v[54:55], v[28:29], v[44:45], v[54:55]
    v_pk_fma_f32 v[50:51], v[22:23], v[38:39], v[50:51]
    v_pk_fma_f32 v[54:55], v[30:31], v[46:47], v[54:55]
    v_cvt_pk_bf16_f32 v62, v50, v51
    v_cvt_pk_bf16_f32 v63, v54, v55
    s_setprio 0
    s_sub_u32 s84, s84, 1
    s_cmp_eq_u32 s84, 0
    s_cbranch_scc1 L2_end_even
    s_waitcnt vmcnt(4)
    ds_read_b64_tr_b16 v[96:97], v159 offset:4096
    ds_read_b64_tr_b16 v[98:99], v159 offset:4608
    ds_read_b64_tr_b16 v[100:101], v159 offset:5120
    ds_read_b64_tr_b16 v[102:103], v159 offset:5632
    ds_read_b64_tr_b16 v[112:113], v160 offset:4096
    ds_read_b64_tr_b16 v[114:115], v160 offset:4608
    ds_read_b64_tr_b16 v[116:117], v160 offset:5120
    ds_read_b64_tr_b16 v[118:119], v160 offset:5632
    ds_read_b64_tr_b16 v[140:141], v156 offset:64
    ds_read_b64_tr_b16 v[136:137], v157
    ds_read2st64_b32 v[134:135], v164 offset0:3 offset1:3
    s_cmp_gt_u32 s84, 3
    s_cselect_b32 s38, 12502, 0
    s_waitcnt lgkmcnt(3)
    s_add_u32 m0, s91, 4096
    s_nop 0
    buffer_load_dwordx4 v[148:149], s[36:39], 0 idxen offen lds
    s_add_u32 m0, m0, 1024
    s_nop 0
    buffer_load_dwordx4 v[150:151], s[36:39], 0 idxen offen lds
    s_add_u32 m0, m0, 1024
    s_nop 0
    buffer_load_dwordx4 v[152:153], s[36:39], 0 idxen offen lds
    s_add_u32 m0, m0, 1024
    s_nop 0
    buffer_load_dwordx4 v[154:155], s[36:39], 0 idxen offen lds
    ds_read_b32 v148, v163 offset:768
    ds_read_b32 v150, v163 offset:800
    ds_read_b32 v152, v163 offset:832
    ds_read_b32 v154, v163 offset:864
    ds_read_b32 v156, v165 offset:128
    s_waitcnt lgkmcnt(5)
    s_branch L2_loopS
L2_ovf:
    ds_write_b32 v63, v62 offset:14604
    v_mov_b32 v163, 0
    v_mov_b32 v164, 0
    v_mov_b32 v165, 0
    s_mov_b32 s38, 0
    v_mov_b32 v33, 0
    v_mov_b32 v35, 0
    v_mov_b32 v37, 0
    v_mov_b32 v39, 0
    s_branch L2_b2
L2_again:
    s_cmp_lg_u32 s96, 0
    s_cselect_b32 s89, 2, s89
    s_cmp_lg_u32 s97, 0
    s_cselect_b32 s83, 1, s83
    s_cselect_b32 s81, 8, s81
    s_cselect_b32 s82, 3, s82
    s_waitcnt vmcnt(0) lgkmcnt(0)
    s_barrier
    s_branch L2_batch
L2_last:
    s_endpgm
.section .rodata,"a"
.p2align 6
.amdhsa_kernel k1_kernel
  .amdhsa_next_free_vgpr 128
  .amdhsa_next_free_sgpr 102
  .amdhsa_accum_offset 128
  .amdhsa_group_segment_fixed_size 0
  .amdhsa_kernarg_size 88
  .amdhsa_user_sgpr_count 2
  .amdhsa_user_sgpr_kernarg_segment_ptr 1
  .amdhsa_system_sgpr_workgroup_id_x 1
.end_amdhsa_kernel
.p2align 6
.amdhsa_kernel k2_kernel
  .amdhsa_next_free_vgpr 168
  .amdhsa_next_free_sgpr 102
  .amdhsa_accum_offset 168
  .amdhsa_group_segment_fixed_size 0
  .amdhsa_kernarg_size 88
  .amdhsa_user_sgpr_count 2
  .amdhsa_user_sgpr_kernarg_segment_ptr 1
  .amdhsa_system_sgpr_workgroup_id_x 1
.end_amdhsa_kernel
```
